```python
import torch

def _softmax(x, axis=-1):
    return torch.softmax(x, dim=axis)
def _gelu(x):
    return torch.nn.functional.gelu(x, approximate="tanh")
def _silu(x):
    return torch.nn.functional.silu(x)
def _sigmoid(x):
    return torch.sigmoid(x)
def _layernorm(x, axis=-1, eps=1e-5):
    m = x.mean(dim=axis, keepdim=True)
    v = x.var(dim=axis, keepdim=True, unbiased=False)
    return (x - m) / torch.sqrt(v + eps)
def _scatter_add(tgt, idx, src, axis=0):
    return tgt.clone().index_add_(axis, idx, src)
def _segment_sum(src, seg, n):
    out = torch.zeros((n,) + src.shape[1:], dtype=src.dtype)
    return out.index_add_(0, seg, src)
def _pad(x, pw):
    flat = tuple(v for pair in reversed(pw) for v in pair)
    return torch.nn.functional.pad(x, flat)

kernel_name = 'parallel_sum__gqa_block_cached__geglu_ffn__decode'

def setup_inputs():

    _w = (lambda a: (lambda t: t.to(torch.bfloat16) if t.is_floating_point() else t)(torch.as_tensor(a)))
    def _A_setup():
        B, Sq, D = 1, 1, 1024
        Hq, Hkv, Sk, Dh = 32, 4, 65536, 128
        assert Hq % Hkv == 0, (Hq, Hkv)
        return {
            "x": _w((lambda *s: torch.randn(*s, dtype=torch.bfloat16) * 0.05)(B, Sq, D)),
            "k_cache": _w((lambda *s: torch.randn(*s, dtype=torch.bfloat16) * 3.2)(B, Hkv, Sk, Dh)),
            "v_cache": _w((lambda *s: torch.randn(*s, dtype=torch.bfloat16) * 1.6)(B, Hkv, Sk, Dh)),
            "wq": _w((lambda *s: torch.randn(*s, dtype=torch.bfloat16) * 3.2)(D, Hq * Dh) * (D ** -0.5)),
            "wo": _w((lambda *s: torch.randn(*s, dtype=torch.bfloat16) * 1.6)(Hq * Dh, D) * ((Hq * Dh) ** -0.5)),
        }
    _A_in = _A_setup()

    def _B_setup():
        B, S, D, F = 1, 1, 1024, 3584
        return {
            "x": _w((lambda *s: torch.randn(*s, dtype=torch.bfloat16) * 0.05)(B, S, D)),
            "w_gate": _w((lambda *s: torch.randn(*s, dtype=torch.bfloat16) * 0.05)(D, F)),
            "w_up": _w((lambda *s: torch.randn(*s, dtype=torch.bfloat16) * 0.05)(D, F)),
            "w_down": _w((lambda *s: torch.randn(*s, dtype=torch.bfloat16) * 0.05)(F, D)),
        }
    _B_in = _B_setup()

    return {
        "A_x": _A_in["x"],
        "A_k_cache": _A_in["k_cache"],
        "A_v_cache": _A_in["v_cache"],
        "A_wq": _A_in["wq"],
        "A_wo": _A_in["wo"],
        "B_x": _B_in["x"],
        "B_w_gate": _B_in["w_gate"],
        "B_w_up": _B_in["w_up"],
        "B_w_down": _B_in["w_down"],
    }

def reference(A_x, A_k_cache, A_v_cache, A_wq, A_wo, B_x, B_w_gate, B_w_up, B_w_down):
    def _A_ref(x, k_cache, v_cache, wq, wo):
        B, Sq, D = x.shape
        Hq, Dh = 32, 128
        Hkv = k_cache.shape[1]
        rep = Hq // Hkv
        q = (lambda x, *d: x.permute(*d))((x @ wq).reshape(B, Sq, Hq, Dh), 0, 2, 1, 3)
        k = (lambda x, n, axis: torch.repeat_interleave(x, n, dim=axis))(k_cache, rep, axis=1)
        v = (lambda x, n, axis: torch.repeat_interleave(x, n, dim=axis))(v_cache, rep, axis=1)
        scores = torch.einsum("bhqd,bhkd->bhqk", q, k) * (Dh ** -0.5)
        p = _softmax(scores, axis=-1)
        o = torch.einsum("bhqk,bhkd->bhqd", p, v)
        return (lambda x, *d: x.permute(*d))(o, 0, 2, 1, 3).reshape(B, Sq, Hq * Dh) @ wo

    def _B_ref(x, w_gate, w_up, w_down):
        return (_gelu(x @ w_gate) * (x @ w_up)) @ w_down

    x = A_x
    xn = _layernorm(x, axis=-1)
    return x + _A_ref(xn, A_k_cache, A_v_cache, A_wq, A_wo) + _B_ref(xn, B_w_gate, B_w_up, B_w_down)
```

```asm
; @launch grid=(256,1,1) block=(512,1,1) lds=55040
.amdgcn_target "amdgcn-amd-amdhsa--gfx950"
.text
.globl parallel_sum__gqa_block_cached__geglu_ffn__decode_kernel
.p2align 8
.type parallel_sum__gqa_block_cached__geglu_ffn__decode_kernel,@function
parallel_sum__gqa_block_cached__geglu_ffn__decode_kernel:
    s_cmp_ge_u32 s2, 256
    s_cbranch_scc1 L_end
    s_load_dwordx16 s[8:23], s[0:1], 0
    s_load_dwordx8 s[24:31], s[0:1], 64
    s_and_b32 s5, s2, 7
    s_lshl_b32 s5, s5, 3
    s_lshr_b32 s6, s2, 3
    s_and_b32 s2, s6, 7
    s_add_u32 s2, s2, s5
    s_lshr_b32 s6, s6, 3
    s_lshl_b32 s6, s6, 6
    s_add_u32 s2, s2, s6
    v_lshrrev_b32 v1, 6, v0
    v_and_b32 v0, 63, v0
    v_readfirstlane_b32 s3, v1
    v_and_b32 v2, 15, v0
    v_lshrrev_b32 v3, 4, v0
    v_bfe_u32 v4, v2, 1, 1
    v_lshlrev_b32 v4, 19, v4
    v_and_b32 v6, 1, v2
    v_lshl_add_u32 v4, v6, 6, v4
    v_lshrrev_b32 v6, 2, v2
    v_lshl_add_u32 v4, v6, 8, v4
    v_lshl_add_u32 v4, v3, 4, v4
    v_lshlrev_b32 v5, 4, v0
    v_mov_b32 v12, 0
    s_lshr_b32 s78, s2, 6
    s_lshl_b32 s4, s78, 24
    s_and_b32 s5, s2, 63
    s_lshl_b32 s5, s5, 13
    s_add_u32 s4, s4, s5
    s_lshl_b32 s5, s3, 10
    s_add_u32 s4, s4, s5
    s_lshr_b32 s76, s2, 3
    s_and_b32 s77, s2, 7
    s_mov_b32 s7, 0
    s_mov_b32 s72, 0x05040100
    s_mov_b32 s73, 0x07060302
    s_mov_b32 s74, 0x3db504f3
    s_mov_b32 s75, 0x3fb8aa3b
    s_waitcnt lgkmcnt(0)
    s_mov_b32 s32, s10
    s_and_b32 s33, s11, 0xffff
    s_mov_b32 s34, 0x4000000
    s_mov_b32 s35, 0x00020000
    s_mov_b32 s36, s12
    s_and_b32 s37, s13, 0xffff
    s_mov_b32 s38, 0x4000000
    s_mov_b32 s39, 0x00020000
    s_mov_b32 s60, s8
    s_and_b32 s61, s9, 0xffff
    s_mov_b32 s62, 0x800
    s_mov_b32 s63, 0x00020000
    s_mov_b32 s40, s14
    s_and_b32 s41, s15, 0xffff
    s_mov_b32 s42, 0x800000
    s_mov_b32 s43, 0x00020000
    s_mov_b32 s44, s16
    s_and_b32 s45, s17, 0xffff
    s_mov_b32 s46, 0x800000
    s_mov_b32 s47, 0x00020000
    s_lshr_b32 s80, s2, 2
    s_and_b32 s81, s2, 3
    s_mul_i32 s95, s81, 28672
    s_lshl_b32 s82, s80, 9
    s_add_u32 s95, s95, s82
    s_add_u32 s95, s95, 0x300000
    s_mul_i32 s94, s81, 1835008
    s_mul_i32 s82, s3, 229376
    s_add_u32 s94, s94, s82
    s_sub_u32 s82, s80, 28
    s_cmp_lt_u32 s80, 28
    s_cselect_b32 s82, s80, s82
    s_lshl_b32 s82, s82, 8
    s_add_u32 s94, s94, s82
    s_cmp_lt_u32 s2, 224
    s_cselect_b32 s94, s94, 0x7f000000
    s_cselect_b32 s95, s95, 0x7f000000
    s_cmp_lt_u32 s80, 28
    s_cselect_b32 s48, s20, s22
    s_cselect_b32 s49, s21, s23
    s_and_b32 s49, s49, 0xffff
    s_mov_b32 s50, 0x700000
    s_mov_b32 s51, 0x00020000
    s_mov_b32 s52, s24
    s_and_b32 s53, s25, 0xffff
    s_mov_b32 s54, 0x700000
    s_mov_b32 s55, 0x00020000
    s_mov_b32 s64, s26
    s_and_b32 s65, s27, 0xffff
    s_mov_b32 s66, 0x800
    s_mov_b32 s67, 0x00020000
    s_mov_b32 s68, s28
    s_and_b32 s69, s29, 0xffff
    s_mov_b32 s70, 0x100
    s_mov_b32 s71, 0x00020000
    s_mov_b32 s56, s30
    s_and_b32 s57, s31, 0xffff
    s_mov_b32 s58, 0x500000
    s_mov_b32 s59, 0x00020000
    s_cmp_eq_u32 s3, 0
    s_cbranch_scc1 L_wave0
    s_mov_b32 s80, 57344
    v_mul_lo_u32 v8, v3, s80
    v_lshl_add_u32 v8, v2, 4, v8
    s_add_u32 s5, s94, 0
    buffer_load_dwordx4 v[64:67], v8, s[48:51], s5 offen nt
    s_add_u32 s5, s94, 7168
    buffer_load_dwordx4 v[68:71], v8, s[48:51], s5 offen nt
    s_add_u32 s5, s94, 14336
    buffer_load_dwordx4 v[72:75], v8, s[48:51], s5 offen nt
    s_add_u32 s5, s94, 21504
    buffer_load_dwordx4 v[76:79], v8, s[48:51], s5 offen nt
    s_barrier
    s_add_u32 s5, s94, 28672
    s_waitcnt vmcnt(3)
    buffer_load_dwordx4 v[80:83], v8, s[48:51], s5 offen nt
    s_add_u32 s5, s94, 35840
    s_waitcnt vmcnt(3)
    buffer_load_dwordx4 v[84:87], v8, s[48:51], s5 offen nt
    s_add_u32 s5, s94, 43008
    s_waitcnt vmcnt(3)
    buffer_load_dwordx4 v[88:91], v8, s[48:51], s5 offen nt
    s_add_u32 s5, s94, 50176
    s_waitcnt vmcnt(3)
    buffer_load_dwordx4 v[92:95], v8, s[48:51], s5 offen nt
    s_add_u32 s5, s4, 0x0
    s_waitcnt vmcnt(3)
    buffer_load_dwordx4 v[128:131], v4, s[32:35], s5 offen offset:0 nt
    s_add_u32 s5, s4, 0x0
    s_waitcnt vmcnt(3)
    buffer_load_dwordx4 v[132:135], v4, s[32:35], s5 offen offset:128 nt
    s_add_u32 s5, s4, 0x100000
    s_waitcnt vmcnt(3)
    buffer_load_dwordx4 v[136:139], v4, s[32:35], s5 offen offset:0 nt
    s_add_u32 s5, s4, 0x100000
    s_waitcnt vmcnt(3)
    buffer_load_dwordx4 v[140:143], v4, s[32:35], s5 offen offset:128 nt
    s_add_u32 s5, s4, 0x200000
    s_waitcnt vmcnt(3)
    buffer_load_dwordx4 v[144:147], v4, s[32:35], s5 offen offset:0 nt
    s_add_u32 s5, s4, 0x200000
    s_waitcnt vmcnt(3)
    buffer_load_dwordx4 v[148:151], v4, s[32:35], s5 offen offset:128 nt
    s_add_u32 s5, s4, 0x300000
    s_waitcnt vmcnt(3)
    buffer_load_dwordx4 v[152:155], v4, s[32:35], s5 offen offset:0 nt
    s_add_u32 s5, s4, 0x300000
    s_waitcnt vmcnt(3)
    buffer_load_dwordx4 v[156:159], v4, s[32:35], s5 offen offset:128 nt
    s_add_u32 s5, s4, 0x400000
    s_waitcnt vmcnt(3)
    buffer_load_dwordx4 v[160:163], v4, s[32:35], s5 offen offset:0 nt
    s_add_u32 s5, s4, 0x400000
    s_waitcnt vmcnt(3)
    buffer_load_dwordx4 v[164:167], v4, s[32:35], s5 offen offset:128 nt
    s_add_u32 s5, s4, 0x500000
    s_waitcnt vmcnt(3)
    buffer_load_dwordx4 v[168:171], v4, s[32:35], s5 offen offset:0 nt
    s_add_u32 s5, s4, 0x500000
    s_waitcnt vmcnt(3)
    buffer_load_dwordx4 v[172:175], v4, s[32:35], s5 offen offset:128 nt
    s_add_u32 s5, s4, 0x600000
    s_waitcnt vmcnt(3)
    buffer_load_dwordx4 v[176:179], v4, s[32:35], s5 offen offset:0 nt
    s_add_u32 s5, s4, 0x600000
    s_waitcnt vmcnt(3)
    buffer_load_dwordx4 v[180:183], v4, s[32:35], s5 offen offset:128 nt
    s_add_u32 s5, s4, 0x700000
    s_waitcnt vmcnt(3)
    buffer_load_dwordx4 v[184:187], v4, s[32:35], s5 offen offset:0 nt
    s_add_u32 s5, s4, 0x700000
    s_waitcnt vmcnt(3)
    buffer_load_dwordx4 v[188:191], v4, s[32:35], s5 offen offset:128 nt
L_fl_1:
    ds_read_b32 v6, v12 offset:4096
    s_waitcnt lgkmcnt(0)
    v_readfirstlane_b32 s80, v6
    s_nop 3
    s_cmp_ge_u32 s80, 1
    s_cbranch_scc1 L_fld_2
    s_add_u32 s7, s7, 1
    s_cmp_ge_u32 s7, 200000
    s_cbranch_scc1 L_fld_2
    s_sleep 1
    s_branch L_fl_1
L_fld_2:
    v_lshlrev_b32 v6, 4, v3
    s_and_b32 s80, s2, 3
    s_lshl_b32 s80, s80, 9
    s_lshl_b32 s81, s3, 6
    s_add_u32 s80, s80, s81
    v_add_u32 v6, s80, v6
    ds_read_b128 v[16:19], v6 offset:0
    s_waitcnt lgkmcnt(0)
    v_perm_b32 v96, v68, v64, s72
    v_perm_b32 v97, v76, v72, s72
    v_perm_b32 v98, v84, v80, s72
    v_perm_b32 v99, v92, v88, s72
    v_perm_b32 v100, v68, v64, s73
    v_perm_b32 v101, v76, v72, s73
    v_perm_b32 v102, v84, v80, s73
    v_perm_b32 v103, v92, v88, s73
    v_mfma_f32_16x16x32_bf16 v[32:35], v[16:19], v[96:99], 0
    v_perm_b32 v104, v69, v65, s72
    v_perm_b32 v105, v77, v73, s72
    v_perm_b32 v106, v85, v81, s72
    v_perm_b32 v107, v93, v89, s72
    v_mfma_f32_16x16x32_bf16 v[36:39], v[16:19], v[100:103], 0
    v_perm_b32 v108, v69, v65, s73
    v_perm_b32 v109, v77, v73, s73
    v_perm_b32 v110, v85, v81, s73
    v_perm_b32 v111, v93, v89, s73
    v_mfma_f32_16x16x32_bf16 v[40:43], v[16:19], v[104:107], 0
    v_perm_b32 v96, v70, v66, s72
    v_perm_b32 v97, v78, v74, s72
    v_perm_b32 v98, v86, v82, s72
    v_perm_b32 v99, v94, v90, s72
    v_mfma_f32_16x16x32_bf16 v[44:47], v[16:19], v[108:111], 0
    v_perm_b32 v100, v70, v66, s73
    v_perm_b32 v101, v78, v74, s73
    v_perm_b32 v102, v86, v82, s73
    v_perm_b32 v103, v94, v90, s73
    v_mfma_f32_16x16x32_bf16 v[48:51], v[16:19], v[96:99], 0
    v_perm_b32 v104, v71, v67, s72
    v_perm_b32 v105, v79, v75, s72
    v_perm_b32 v106, v87, v83, s72
    v_perm_b32 v107, v95, v91, s72
    v_mfma_f32_16x16x32_bf16 v[52:55], v[16:19], v[100:103], 0
    v_perm_b32 v108, v71, v67, s73
    v_perm_b32 v109, v79, v75, s73
    v_perm_b32 v110, v87, v83, s73
    v_perm_b32 v111, v95, v91, s73
    v_mfma_f32_16x16x32_bf16 v[56:59], v[16:19], v[104:107], 0
    s_nop 0
    v_mfma_f32_16x16x32_bf16 v[60:63], v[16:19], v[108:111], 0
    v_mov_b32 v24, v32
    v_mov_b32 v25, v36
    v_mov_b32 v26, v40
    v_mov_b32 v27, v44
    v_mov_b32 v28, v48
    v_mov_b32 v29, v52
    v_mov_b32 v30, v56
    s_nop 0
    v_mov_b32 v31, v60
    s_lshl_b32 s81, s3, 9
    v_lshlrev_b32 v6, 5, v2
    v_add_u32 v6, s81, v6
    s_mov_b64 exec, 0xffff
    ds_write_b128 v6, v[24:27] offset:50688
    ds_write_b128 v6, v[28:31] offset:50704
    s_mov_b64 exec, 1
    v_mov_b32 v7, 1
    s_waitcnt lgkmcnt(0)
    ds_add_u32 v12, v7 offset:4100
    s_mov_b64 exec, -1
    s_add_u32 s5, s4, 0x800000
    s_waitcnt vmcnt(3)
    buffer_load_dwordx4 v[192:195], v4, s[32:35], s5 offen offset:0 nt
    s_add_u32 s5, s4, 0x800000
    s_waitcnt vmcnt(3)
    buffer_load_dwordx4 v[196:199], v4, s[32:35], s5 offen offset:128 nt
    s_add_u32 s5, s4, 0x900000
    s_waitcnt vmcnt(3)
    buffer_load_dwordx4 v[200:203], v4, s[32:35], s5 offen offset:0 nt
    s_add_u32 s5, s4, 0x900000
    s_waitcnt vmcnt(3)
    buffer_load_dwordx4 v[204:207], v4, s[32:35], s5 offen offset:128 nt
    s_add_u32 s5, s4, 0xa00000
    s_waitcnt vmcnt(3)
    buffer_load_dwordx4 v[208:211], v4, s[32:35], s5 offen offset:0 nt
    s_add_u32 s5, s4, 0xa00000
    s_waitcnt vmcnt(3)
    buffer_load_dwordx4 v[212:215], v4, s[32:35], s5 offen offset:128 nt
    s_add_u32 s5, s4, 0xb00000
    s_waitcnt vmcnt(3)
    buffer_load_dwordx4 v[216:219], v4, s[32:35], s5 offen offset:0 nt
    s_add_u32 s5, s4, 0xb00000
    s_waitcnt vmcnt(3)
    buffer_load_dwordx4 v[220:223], v4, s[32:35], s5 offen offset:128 nt
    s_add_u32 s5, s4, 0xc00000
    s_waitcnt vmcnt(3)
    buffer_load_dwordx4 v[224:227], v4, s[32:35], s5 offen offset:0 nt
    s_add_u32 s5, s4, 0xc00000
    s_waitcnt vmcnt(3)
    buffer_load_dwordx4 v[228:231], v4, s[32:35], s5 offen offset:128 nt
    s_add_u32 s5, s4, 0xd00000
    s_waitcnt vmcnt(3)
    buffer_load_dwordx4 v[232:235], v4, s[32:35], s5 offen offset:0 nt
    s_add_u32 s5, s4, 0xd00000
    s_waitcnt vmcnt(3)
    buffer_load_dwordx4 v[236:239], v4, s[32:35], s5 offen offset:128 nt
    s_add_u32 s5, s4, 0xe00000
    s_waitcnt vmcnt(3)
    buffer_load_dwordx4 v[240:243], v4, s[32:35], s5 offen offset:0 nt
    s_add_u32 s5, s4, 0xe00000
    s_waitcnt vmcnt(3)
    buffer_load_dwordx4 v[244:247], v4, s[32:35], s5 offen offset:128 nt
    s_add_u32 s5, s4, 0xf00000
    s_waitcnt vmcnt(3)
    buffer_load_dwordx4 v[248:251], v4, s[32:35], s5 offen offset:0 nt
    s_add_u32 s5, s4, 0xf00000
    s_waitcnt vmcnt(3)
    buffer_load_dwordx4 v[252:255], v4, s[32:35], s5 offen offset:128 nt
    s_add_u32 s6, s4, 0x0
    s_waitcnt vmcnt(3)
    buffer_load_dwordx4 v[64:67], v5, s[36:39], s6 offen nt
    s_add_u32 s6, s4, 0x80000
    s_waitcnt vmcnt(3)
    buffer_load_dwordx4 v[68:71], v5, s[36:39], s6 offen nt
    s_add_u32 s6, s4, 0x100000
    s_waitcnt vmcnt(3)
    buffer_load_dwordx4 v[72:75], v5, s[36:39], s6 offen nt
    s_add_u32 s6, s4, 0x180000
    s_waitcnt vmcnt(3)
    buffer_load_dwordx4 v[76:79], v5, s[36:39], s6 offen nt
    s_add_u32 s6, s4, 0x200000
    s_waitcnt vmcnt(3)
    buffer_load_dwordx4 v[80:83], v5, s[36:39], s6 offen nt
    s_add_u32 s6, s4, 0x280000
    s_waitcnt vmcnt(3)
    buffer_load_dwordx4 v[84:87], v5, s[36:39], s6 offen nt
L_fl_3:
    ds_read_b32 v6, v12 offset:4096
    s_waitcnt lgkmcnt(0)
    v_readfirstlane_b32 s80, v6
    s_nop 3
    s_cmp_ge_u32 s80, 2
    s_cbranch_scc1 L_fld_4
    s_add_u32 s7, s7, 1
    s_cmp_ge_u32 s7, 200000
    s_cbranch_scc1 L_fld_4
    s_sleep 1
    s_branch L_fl_3
L_fld_4:
    v_and_b32 v6, 7, v2
    v_lshlrev_b32 v6, 8, v6
    v_lshl_add_u32 v6, v3, 4, v6
    v_lshrrev_b32 v7, 3, v2
    v_lshl_add_u32 v6, v7, 6, v6
    ds_read_b128 v[16:19], v6 offset:2048
    ds_read_b128 v[20:23], v6 offset:2176
    s_waitcnt lgkmcnt(0)
    v_mfma_f32_16x16x32_bf16 v[24:27], v[128:131], v[16:19], 0
    v_mfma_f32_16x16x32_bf16 v[24:27], v[132:135], v[20:23], v[24:27]
    v_mfma_f32_16x16x32_bf16 v[128:131], v[136:139], v[16:19], 0
    v_mfma_f32_16x16x32_bf16 v[128:131], v[140:143], v[20:23], v[128:131]
    v_mfma_f32_16x16x32_bf16 v[136:139], v[144:147], v[16:19], 0
    v_mfma_f32_16x16x32_bf16 v[136:139], v[148:151], v[20:23], v[136:139]
    v_mfma_f32_16x16x32_bf16 v[144:147], v[152:155], v[16:19], 0
    v_mfma_f32_16x16x32_bf16 v[144:147], v[156:159], v[20:23], v[144:147]
    s_nop 1
    v_add_f32_dpp v32, v25, v24 row_ror:8 row_mask:0xf bank_mask:0xf
    v_add_f32_dpp v33, v27, v26 row_ror:8 row_mask:0xf bank_mask:0xf
    v_mfma_f32_16x16x32_bf16 v[152:155], v[160:163], v[16:19], 0
    v_mfma_f32_16x16x32_bf16 v[152:155], v[164:167], v[20:23], v[152:155]
    v_add_f32_dpp v34, v129, v128 row_ror:8 row_mask:0xf bank_mask:0xf
    v_add_f32_dpp v35, v131, v130 row_ror:8 row_mask:0xf bank_mask:0xf
    v_mfma_f32_16x16x32_bf16 v[160:163], v[168:171], v[16:19], 0
    v_mfma_f32_16x16x32_bf16 v[160:163], v[172:175], v[20:23], v[160:163]
    v_add_f32_dpp v36, v137, v136 row_ror:8 row_mask:0xf bank_mask:0xf
    v_add_f32_dpp v37, v139, v138 row_ror:8 row_mask:0xf bank_mask:0xf
    v_mfma_f32_16x16x32_bf16 v[168:171], v[176:179], v[16:19], 0
    v_mfma_f32_16x16x32_bf16 v[168:171], v[180:183], v[20:23], v[168:171]
    v_add_f32_dpp v38, v145, v144 row_ror:8 row_mask:0xf bank_mask:0xf
    v_add_f32_dpp v39, v147, v146 row_ror:8 row_mask:0xf bank_mask:0xf
    v_mfma_f32_16x16x32_bf16 v[176:179], v[184:187], v[16:19], 0
    v_mfma_f32_16x16x32_bf16 v[176:179], v[188:191], v[20:23], v[176:179]
    v_add_f32_dpp v40, v153, v152 row_ror:8 row_mask:0xf bank_mask:0xf
    v_add_f32_dpp v41, v155, v154 row_ror:8 row_mask:0xf bank_mask:0xf
    v_mfma_f32_16x16x32_bf16 v[184:187], v[192:195], v[16:19], 0
    v_mfma_f32_16x16x32_bf16 v[184:187], v[196:199], v[20:23], v[184:187]
    v_add_f32_dpp v42, v161, v160 row_ror:8 row_mask:0xf bank_mask:0xf
    v_add_f32_dpp v43, v163, v162 row_ror:8 row_mask:0xf bank_mask:0xf
    v_mfma_f32_16x16x32_bf16 v[192:195], v[200:203], v[16:19], 0
    v_mfma_f32_16x16x32_bf16 v[192:195], v[204:207], v[20:23], v[192:195]
    v_add_f32_dpp v44, v169, v168 row_ror:8 row_mask:0xf bank_mask:0xf
    v_add_f32_dpp v45, v171, v170 row_ror:8 row_mask:0xf bank_mask:0xf
    v_mfma_f32_16x16x32_bf16 v[200:203], v[208:211], v[16:19], 0
    v_mfma_f32_16x16x32_bf16 v[200:203], v[212:215], v[20:23], v[200:203]
    v_add_f32_dpp v46, v177, v176 row_ror:8 row_mask:0xf bank_mask:0xf
    v_add_f32_dpp v47, v179, v178 row_ror:8 row_mask:0xf bank_mask:0xf
    v_mfma_f32_16x16x32_bf16 v[208:211], v[216:219], v[16:19], 0
    v_mfma_f32_16x16x32_bf16 v[208:211], v[220:223], v[20:23], v[208:211]
    v_add_f32_dpp v48, v185, v184 row_ror:8 row_mask:0xf bank_mask:0xf
    v_add_f32_dpp v49, v187, v186 row_ror:8 row_mask:0xf bank_mask:0xf
    v_mfma_f32_16x16x32_bf16 v[216:219], v[224:227], v[16:19], 0
    v_mfma_f32_16x16x32_bf16 v[216:219], v[228:231], v[20:23], v[216:219]
    v_add_f32_dpp v50, v193, v192 row_ror:8 row_mask:0xf bank_mask:0xf
    v_add_f32_dpp v51, v195, v194 row_ror:8 row_mask:0xf bank_mask:0xf
    v_mfma_f32_16x16x32_bf16 v[224:227], v[232:235], v[16:19], 0
    v_mfma_f32_16x16x32_bf16 v[224:227], v[236:239], v[20:23], v[224:227]
    v_add_f32_dpp v52, v201, v200 row_ror:8 row_mask:0xf bank_mask:0xf
    v_add_f32_dpp v53, v203, v202 row_ror:8 row_mask:0xf bank_mask:0xf
    v_mfma_f32_16x16x32_bf16 v[232:235], v[240:243], v[16:19], 0
    v_mfma_f32_16x16x32_bf16 v[232:235], v[244:247], v[20:23], v[232:235]
    v_add_f32_dpp v54, v209, v208 row_ror:8 row_mask:0xf bank_mask:0xf
    v_add_f32_dpp v55, v211, v210 row_ror:8 row_mask:0xf bank_mask:0xf
    v_mfma_f32_16x16x32_bf16 v[240:243], v[248:251], v[16:19], 0
    v_mfma_f32_16x16x32_bf16 v[240:243], v[252:255], v[20:23], v[240:243]
    v_add_f32_dpp v56, v217, v216 row_ror:8 row_mask:0xf bank_mask:0xf
    v_add_f32_dpp v57, v219, v218 row_ror:8 row_mask:0xf bank_mask:0xf
    v_add_f32_dpp v58, v225, v224 row_ror:8 row_mask:0xf bank_mask:0xf
    v_add_f32_dpp v59, v227, v226 row_ror:8 row_mask:0xf bank_mask:0xf
    v_add_f32_dpp v60, v233, v232 row_ror:8 row_mask:0xf bank_mask:0xf
    v_add_f32_dpp v61, v235, v234 row_ror:8 row_mask:0xf bank_mask:0xf
    s_nop 1
    v_add_f32_dpp v62, v241, v240 row_ror:8 row_mask:0xf bank_mask:0xf
    v_add_f32_dpp v63, v243, v242 row_ror:8 row_mask:0xf bank_mask:0xf
    v_cvt_pk_bf16_f32 v6, v32, v33
    v_lshlrev_b32 v32, 16, v6
    v_and_b32 v33, 0xffff0000, v6
    v_mul_f32 v32, s74, v32
    v_mul_f32 v33, s74, v33
    v_cvt_pk_bf16_f32 v7, v32, v33
    v_lshlrev_b32 v32, 16, v7
    v_and_b32 v33, 0xffff0000, v7
    v_max_f32 v14, v32, v33
    v_cvt_pk_bf16_f32 v6, v34, v35
    v_lshlrev_b32 v34, 16, v6
    v_and_b32 v35, 0xffff0000, v6
    v_mul_f32 v34, s74, v34
    v_mul_f32 v35, s74, v35
    v_cvt_pk_bf16_f32 v7, v34, v35
    v_lshlrev_b32 v34, 16, v7
    v_and_b32 v35, 0xffff0000, v7
    v_max3_f32 v14, v14, v34, v35
    v_cvt_pk_bf16_f32 v6, v36, v37
    v_lshlrev_b32 v36, 16, v6
    v_and_b32 v37, 0xffff0000, v6
    v_mul_f32 v36, s74, v36
    v_mul_f32 v37, s74, v37
    v_cvt_pk_bf16_f32 v7, v36, v37
    v_lshlrev_b32 v36, 16, v7
    v_and_b32 v37, 0xffff0000, v7
    v_max3_f32 v14, v14, v36, v37
    v_cvt_pk_bf16_f32 v6, v38, v39
    v_lshlrev_b32 v38, 16, v6
    v_and_b32 v39, 0xffff0000, v6
    v_mul_f32 v38, s74, v38
    v_mul_f32 v39, s74, v39
    v_cvt_pk_bf16_f32 v7, v38, v39
    v_lshlrev_b32 v38, 16, v7
    v_and_b32 v39, 0xffff0000, v7
    v_max3_f32 v14, v14, v38, v39
    s_add_u32 s6, s4, 0x300000
    s_waitcnt vmcnt(3)
    buffer_load_dwordx4 v[88:91], v5, s[36:39], s6 offen nt
    v_cvt_pk_bf16_f32 v6, v40, v41
    v_lshlrev_b32 v40, 16, v6
    v_and_b32 v41, 0xffff0000, v6
    v_mul_f32 v40, s74, v40
    v_mul_f32 v41, s74, v41
    v_cvt_pk_bf16_f32 v7, v40, v41
    v_lshlrev_b32 v40, 16, v7
    v_and_b32 v41, 0xffff0000, v7
    v_max3_f32 v14, v14, v40, v41
    v_cvt_pk_bf16_f32 v6, v42, v43
    v_lshlrev_b32 v42, 16, v6
    v_and_b32 v43, 0xffff0000, v6
    v_mul_f32 v42, s74, v42
    v_mul_f32 v43, s74, v43
    v_cvt_pk_bf16_f32 v7, v42, v43
    v_lshlrev_b32 v42, 16, v7
    v_and_b32 v43, 0xffff0000, v7
    v_max3_f32 v14, v14, v42, v43
    v_cvt_pk_bf16_f32 v6, v44, v45
    v_lshlrev_b32 v44, 16, v6
    v_and_b32 v45, 0xffff0000, v6
    v_mul_f32 v44, s74, v44
    v_mul_f32 v45, s74, v45
    v_cvt_pk_bf16_f32 v7, v44, v45
    v_lshlrev_b32 v44, 16, v7
    v_and_b32 v45, 0xffff0000, v7
    v_max3_f32 v14, v14, v44, v45
    v_cvt_pk_bf16_f32 v6, v46, v47
    v_lshlrev_b32 v46, 16, v6
    v_and_b32 v47, 0xffff0000, v6
    v_mul_f32 v46, s74, v46
    v_mul_f32 v47, s74, v47
    v_cvt_pk_bf16_f32 v7, v46, v47
    v_lshlrev_b32 v46, 16, v7
    v_and_b32 v47, 0xffff0000, v7
    v_max3_f32 v14, v14, v46, v47
    s_add_u32 s6, s4, 0x380000
    s_waitcnt vmcnt(3)
    buffer_load_dwordx4 v[92:95], v5, s[36:39], s6 offen nt
    v_cvt_pk_bf16_f32 v6, v48, v49
    v_lshlrev_b32 v48, 16, v6
    v_and_b32 v49, 0xffff0000, v6
    v_mul_f32 v48, s74, v48
    v_mul_f32 v49, s74, v49
    v_cvt_pk_bf16_f32 v7, v48, v49
    v_lshlrev_b32 v48, 16, v7
    v_and_b32 v49, 0xffff0000, v7
    v_max3_f32 v14, v14, v48, v49
    v_cvt_pk_bf16_f32 v6, v50, v51
    v_lshlrev_b32 v50, 16, v6
    v_and_b32 v51, 0xffff0000, v6
    v_mul_f32 v50, s74, v50
    v_mul_f32 v51, s74, v51
    v_cvt_pk_bf16_f32 v7, v50, v51
    v_lshlrev_b32 v50, 16, v7
    v_and_b32 v51, 0xffff0000, v7
    v_max3_f32 v14, v14, v50, v51
    v_cvt_pk_bf16_f32 v6, v52, v53
    v_lshlrev_b32 v52, 16, v6
    v_and_b32 v53, 0xffff0000, v6
    v_mul_f32 v52, s74, v52
    v_mul_f32 v53, s74, v53
    v_cvt_pk_bf16_f32 v7, v52, v53
    v_lshlrev_b32 v52, 16, v7
    v_and_b32 v53, 0xffff0000, v7
    v_max3_f32 v14, v14, v52, v53
    v_cvt_pk_bf16_f32 v6, v54, v55
    v_lshlrev_b32 v54, 16, v6
    v_and_b32 v55, 0xffff0000, v6
    v_mul_f32 v54, s74, v54
    v_mul_f32 v55, s74, v55
    v_cvt_pk_bf16_f32 v7, v54, v55
    v_lshlrev_b32 v54, 16, v7
    v_and_b32 v55, 0xffff0000, v7
    v_max3_f32 v14, v14, v54, v55
    s_add_u32 s6, s4, 0x400000
    s_waitcnt vmcnt(3)
    buffer_load_dwordx4 v[96:99], v5, s[36:39], s6 offen nt
    v_cvt_pk_bf16_f32 v6, v56, v57
    v_lshlrev_b32 v56, 16, v6
    v_and_b32 v57, 0xffff0000, v6
    v_mul_f32 v56, s74, v56
    v_mul_f32 v57, s74, v57
    v_cvt_pk_bf16_f32 v7, v56, v57
    v_lshlrev_b32 v56, 16, v7
    v_and_b32 v57, 0xffff0000, v7
    v_max3_f32 v14, v14, v56, v57
    v_cvt_pk_bf16_f32 v6, v58, v59
    v_lshlrev_b32 v58, 16, v6
    v_and_b32 v59, 0xffff0000, v6
    v_mul_f32 v58, s74, v58
    v_mul_f32 v59, s74, v59
    v_cvt_pk_bf16_f32 v7, v58, v59
    v_lshlrev_b32 v58, 16, v7
    v_and_b32 v59, 0xffff0000, v7
    v_max3_f32 v14, v14, v58, v59
    v_cvt_pk_bf16_f32 v6, v60, v61
    v_lshlrev_b32 v60, 16, v6
    v_and_b32 v61, 0xffff0000, v6
    v_mul_f32 v60, s74, v60
    v_mul_f32 v61, s74, v61
    v_cvt_pk_bf16_f32 v7, v60, v61
    v_lshlrev_b32 v60, 16, v7
    v_and_b32 v61, 0xffff0000, v7
    v_max3_f32 v14, v14, v60, v61
    v_cvt_pk_bf16_f32 v6, v62, v63
    v_lshlrev_b32 v62, 16, v6
    v_and_b32 v63, 0xffff0000, v6
    v_mul_f32 v62, s74, v62
    v_mul_f32 v63, s74, v63
    v_cvt_pk_bf16_f32 v7, v62, v63
    v_lshlrev_b32 v62, 16, v7
    v_and_b32 v63, 0xffff0000, v7
    v_max3_f32 v14, v14, v62, v63
    s_add_u32 s6, s4, 0x480000
    s_waitcnt vmcnt(3)
    buffer_load_dwordx4 v[100:103], v5, s[36:39], s6 offen nt
    v_mov_b32 v6, v14
    s_nop 1
    v_permlane16_swap_b32 v14, v6
    v_max_f32 v14, v14, v6
    v_mov_b32 v6, v14
    s_nop 1
    v_permlane32_swap_b32 v14, v6
    v_max_f32 v14, v14, v6
    v_sub_f32 v32, v32, v14
    v_mul_f32 v32, s75, v32
    v_exp_f32 v32, v32
    v_sub_f32 v33, v33, v14
    v_mul_f32 v33, s75, v33
    v_exp_f32 v33, v33
    v_sub_f32 v34, v34, v14
    v_mul_f32 v34, s75, v34
    v_exp_f32 v34, v34
    v_sub_f32 v35, v35, v14
    v_mul_f32 v35, s75, v35
    v_exp_f32 v35, v35
    v_sub_f32 v36, v36, v14
    v_mul_f32 v36, s75, v36
    v_exp_f32 v36, v36
    v_sub_f32 v37, v37, v14
    v_mul_f32 v37, s75, v37
    v_exp_f32 v37, v37
    v_sub_f32 v38, v38, v14
    v_mul_f32 v38, s75, v38
    v_exp_f32 v38, v38
    v_sub_f32 v39, v39, v14
    v_mul_f32 v39, s75, v39
    v_exp_f32 v39, v39
    s_add_u32 s6, s4, 0x500000
    s_waitcnt vmcnt(3)
    buffer_load_dwordx4 v[104:107], v5, s[36:39], s6 offen nt
    v_sub_f32 v40, v40, v14
    v_mul_f32 v40, s75, v40
    v_exp_f32 v40, v40
    v_sub_f32 v41, v41, v14
    v_mul_f32 v41, s75, v41
    v_exp_f32 v41, v41
    v_sub_f32 v42, v42, v14
    v_mul_f32 v42, s75, v42
    v_exp_f32 v42, v42
    v_sub_f32 v43, v43, v14
    v_mul_f32 v43, s75, v43
    v_exp_f32 v43, v43
    v_sub_f32 v44, v44, v14
    v_mul_f32 v44, s75, v44
    v_exp_f32 v44, v44
    v_sub_f32 v45, v45, v14
    v_mul_f32 v45, s75, v45
    v_exp_f32 v45, v45
    v_sub_f32 v46, v46, v14
    v_mul_f32 v46, s75, v46
    v_exp_f32 v46, v46
    v_sub_f32 v47, v47, v14
    v_mul_f32 v47, s75, v47
    v_exp_f32 v47, v47
    s_add_u32 s6, s4, 0x580000
    s_waitcnt vmcnt(3)
    buffer_load_dwordx4 v[108:111], v5, s[36:39], s6 offen nt
    v_sub_f32 v48, v48, v14
    v_mul_f32 v48, s75, v48
    v_exp_f32 v48, v48
    v_sub_f32 v49, v49, v14
    v_mul_f32 v49, s75, v49
    v_exp_f32 v49, v49
    v_sub_f32 v50, v50, v14
    v_mul_f32 v50, s75, v50
    v_exp_f32 v50, v50
    v_sub_f32 v51, v51, v14
    v_mul_f32 v51, s75, v51
    v_exp_f32 v51, v51
    v_sub_f32 v52, v52, v14
    v_mul_f32 v52, s75, v52
    v_exp_f32 v52, v52
    v_sub_f32 v53, v53, v14
    v_mul_f32 v53, s75, v53
    v_exp_f32 v53, v53
    v_sub_f32 v54, v54, v14
    v_mul_f32 v54, s75, v54
    v_exp_f32 v54, v54
    v_sub_f32 v55, v55, v14
    v_mul_f32 v55, s75, v55
    v_exp_f32 v55, v55
    s_add_u32 s6, s4, 0x600000
    s_waitcnt vmcnt(3)
    buffer_load_dwordx4 v[112:115], v5, s[36:39], s6 offen nt
    v_sub_f32 v56, v56, v14
    v_mul_f32 v56, s75, v56
    v_exp_f32 v56, v56
    v_sub_f32 v57, v57, v14
    v_mul_f32 v57, s75, v57
    v_exp_f32 v57, v57
    v_sub_f32 v58, v58, v14
    v_mul_f32 v58, s75, v58
    v_exp_f32 v58, v58
    v_sub_f32 v59, v59, v14
    v_mul_f32 v59, s75, v59
    v_exp_f32 v59, v59
    v_sub_f32 v60, v60, v14
    v_mul_f32 v60, s75, v60
    v_exp_f32 v60, v60
    v_sub_f32 v61, v61, v14
    v_mul_f32 v61, s75, v61
    v_exp_f32 v61, v61
    v_sub_f32 v62, v62, v14
    v_mul_f32 v62, s75, v62
    v_exp_f32 v62, v62
    v_sub_f32 v63, v63, v14
    v_mul_f32 v63, s75, v63
    v_exp_f32 v63, v63
    s_add_u32 s6, s4, 0x680000
    s_waitcnt vmcnt(3)
    buffer_load_dwordx4 v[116:119], v5, s[36:39], s6 offen nt
    v_add_f32 v15, v32, v33
    v_add_f32 v15, v15, v34
    v_add_f32 v15, v15, v35
    v_add_f32 v15, v15, v36
    v_add_f32 v15, v15, v37
    v_add_f32 v15, v15, v38
    v_add_f32 v15, v15, v39
    v_add_f32 v15, v15, v40
    v_add_f32 v15, v15, v41
    v_add_f32 v15, v15, v42
    v_add_f32 v15, v15, v43
    v_add_f32 v15, v15, v44
    v_add_f32 v15, v15, v45
    v_add_f32 v15, v15, v46
    v_add_f32 v15, v15, v47
    v_add_f32 v15, v15, v48
    v_add_f32 v15, v15, v49
    v_add_f32 v15, v15, v50
    v_add_f32 v15, v15, v51
    v_add_f32 v15, v15, v52
    v_add_f32 v15, v15, v53
    v_add_f32 v15, v15, v54
    v_add_f32 v15, v15, v55
    v_add_f32 v15, v15, v56
    v_add_f32 v15, v15, v57
    v_add_f32 v15, v15, v58
    v_add_f32 v15, v15, v59
    v_add_f32 v15, v15, v60
    v_add_f32 v15, v15, v61
    v_add_f32 v15, v15, v62
    v_add_f32 v15, v15, v63
    v_cvt_pk_bf16_f32 v240, v32, v33
    v_cvt_pk_bf16_f32 v241, v34, v35
    v_cvt_pk_bf16_f32 v242, v36, v37
    v_cvt_pk_bf16_f32 v243, v38, v39
    v_cvt_pk_bf16_f32 v244, v40, v41
    v_cvt_pk_bf16_f32 v245, v42, v43
    v_cvt_pk_bf16_f32 v246, v44, v45
    v_cvt_pk_bf16_f32 v247, v46, v47
    v_cvt_pk_bf16_f32 v248, v48, v49
    v_cvt_pk_bf16_f32 v249, v50, v51
    v_cvt_pk_bf16_f32 v250, v52, v53
    v_cvt_pk_bf16_f32 v251, v54, v55
    v_cvt_pk_bf16_f32 v252, v56, v57
    v_cvt_pk_bf16_f32 v253, v58, v59
    v_cvt_pk_bf16_f32 v254, v60, v61
    v_cvt_pk_bf16_f32 v255, v62, v63
    v_mov_b32 v6, v15
    s_nop 1
    v_permlane16_swap_b32 v15, v6
    v_add_f32 v15, v15, v6
    v_mov_b32 v6, v15
    s_nop 1
    v_permlane32_swap_b32 v15, v6
    v_add_f32 v15, v15, v6
    s_nop 1
L_fl_5:
    ds_read_b32 v6, v12 offset:4096
    s_waitcnt lgkmcnt(0)
    v_readfirstlane_b32 s80, v6
    s_nop 3
    s_cmp_ge_u32 s80, 3
    s_cbranch_scc1 L_fld_6
    s_add_u32 s7, s7, 1
    s_cmp_ge_u32 s7, 200000
    s_cbranch_scc1 L_fld_6
    s_sleep 1
    s_branch L_fl_5
L_fld_6:
    v_lshlrev_b32 v10, 13, v3
    v_lshl_add_u32 v10, v2, 4, v10
    s_mul_i32 s80, s76, 112
    s_lshl_b32 s81, s3, 4
    s_add_u32 s80, s80, s81
    s_sub_u32 s84, s80, 16
    s_lshl_b32 s80, s84, 11
    s_lshl_b32 s81, s77, 8
    s_add_u32 s80, s80, s81
    s_add_u32 s5, s80, 0
    s_waitcnt vmcnt(3)
    buffer_load_dwordx4 v[32:35], v10, s[52:55], s5 offen nt
    s_add_u32 s5, s80, 2048
    s_waitcnt vmcnt(3)
    buffer_load_dwordx4 v[36:39], v10, s[52:55], s5 offen nt
    s_add_u32 s5, s80, 4096
    s_waitcnt vmcnt(3)
    buffer_load_dwordx4 v[40:43], v10, s[52:55], s5 offen nt
    s_add_u32 s5, s80, 6144
    s_waitcnt vmcnt(3)
    buffer_load_dwordx4 v[44:47], v10, s[52:55], s5 offen nt
    v_and_b32 v11, 3, v2
    s_mov_b32 s5, 28672
    v_mul_lo_u32 v11, v11, s5
    v_bfe_u32 v6, v2, 2, 1
    s_mov_b32 s5, 14336
    v_mul_lo_u32 v6, v6, s5
    v_add_u32 v11, v11, v6
    v_lshl_add_u32 v11, v3, 4, v11
    s_lshl_b32 s90, s84, 2
    s_add_u32 s90, s90, 0x300000
    s_waitcnt vmcnt(3)
    buffer_load_dwordx4 v[48:51], v11, s[56:59], s90 offen sc1
    s_add_u32 s6, s4, 0x700000
    s_waitcnt vmcnt(3)
    buffer_load_dwordx4 v[120:123], v5, s[36:39], s6 offen nt
    s_add_u32 s6, s4, 0x780000
    s_waitcnt vmcnt(3)
    buffer_load_dwordx4 v[124:127], v5, s[36:39], s6 offen nt
    v_perm_b32 v224, v68, v64, s72
    v_perm_b32 v225, v76, v72, s72
    v_perm_b32 v226, v84, v80, s72
    v_perm_b32 v227, v92, v88, s72
    v_perm_b32 v228, v68, v64, s73
    v_perm_b32 v229, v76, v72, s73
    v_perm_b32 v230, v84, v80, s73
    v_perm_b32 v231, v92, v88, s73
    v_mfma_f32_16x16x32_bf16 v[192:195], v[224:227], v[240:243], 0
    v_perm_b32 v232, v69, v65, s72
    v_perm_b32 v233, v77, v73, s72
    v_perm_b32 v234, v85, v81, s72
    v_perm_b32 v235, v93, v89, s72
    v_mfma_f32_16x16x32_bf16 v[196:199], v[228:231], v[240:243], 0
    v_perm_b32 v236, v69, v65, s73
    v_perm_b32 v237, v77, v73, s73
    v_perm_b32 v238, v85, v81, s73
    v_perm_b32 v239, v93, v89, s73
    v_mfma_f32_16x16x32_bf16 v[200:203], v[232:235], v[240:243], 0
    v_perm_b32 v224, v70, v66, s72
    v_perm_b32 v225, v78, v74, s72
    v_perm_b32 v226, v86, v82, s72
    v_perm_b32 v227, v94, v90, s72
    v_mfma_f32_16x16x32_bf16 v[204:207], v[236:239], v[240:243], 0
    v_perm_b32 v228, v70, v66, s73
    v_perm_b32 v229, v78, v74, s73
    v_perm_b32 v230, v86, v82, s73
    v_perm_b32 v231, v94, v90, s73
    v_mfma_f32_16x16x32_bf16 v[208:211], v[224:227], v[240:243], 0
    v_perm_b32 v232, v71, v67, s72
    v_perm_b32 v233, v79, v75, s72
    v_perm_b32 v234, v87, v83, s72
    v_perm_b32 v235, v95, v91, s72
    v_mfma_f32_16x16x32_bf16 v[212:215], v[228:231], v[240:243], 0
    v_perm_b32 v236, v71, v67, s73
    v_perm_b32 v237, v79, v75, s73
    v_perm_b32 v238, v87, v83, s73
    v_perm_b32 v239, v95, v91, s73
    v_mfma_f32_16x16x32_bf16 v[216:219], v[232:235], v[240:243], 0
    s_nop 0
    v_mfma_f32_16x16x32_bf16 v[220:223], v[236:239], v[240:243], 0
    s_add_u32 s6, s4, 0x800000
    s_waitcnt vmcnt(3)
    buffer_load_dwordx4 v[128:131], v5, s[36:39], s6 offen nt
    s_add_u32 s6, s4, 0x880000
    s_waitcnt vmcnt(3)
    buffer_load_dwordx4 v[132:135], v5, s[36:39], s6 offen nt
    s_add_u32 s6, s4, 0x900000
    s_waitcnt vmcnt(3)
    buffer_load_dwordx4 v[136:139], v5, s[36:39], s6 offen nt
    s_add_u32 s6, s4, 0x980000
    s_waitcnt vmcnt(3)
    buffer_load_dwordx4 v[140:143], v5, s[36:39], s6 offen nt
    s_add_u32 s6, s4, 0xa00000
    s_waitcnt vmcnt(3)
    buffer_load_dwordx4 v[144:147], v5, s[36:39], s6 offen nt
    s_add_u32 s6, s4, 0xa80000
    s_waitcnt vmcnt(3)
    buffer_load_dwordx4 v[148:151], v5, s[36:39], s6 offen nt
    s_add_u32 s6, s4, 0xb00000
    s_waitcnt vmcnt(3)
    buffer_load_dwordx4 v[152:155], v5, s[36:39], s6 offen nt
    s_add_u32 s6, s4, 0xb80000
    s_waitcnt vmcnt(3)
    buffer_load_dwordx4 v[156:159], v5, s[36:39], s6 offen nt
    v_perm_b32 v224, v100, v96, s72
    v_perm_b32 v225, v108, v104, s72
    v_perm_b32 v226, v116, v112, s72
    v_perm_b32 v227, v124, v120, s72
    v_perm_b32 v228, v100, v96, s73
    v_perm_b32 v229, v108, v104, s73
    v_perm_b32 v230, v116, v112, s73
    v_perm_b32 v231, v124, v120, s73
    v_mfma_f32_16x16x32_bf16 v[192:195], v[224:227], v[244:247], v[192:195]
    v_perm_b32 v232, v101, v97, s72
    v_perm_b32 v233, v109, v105, s72
    v_perm_b32 v234, v117, v113, s72
    v_perm_b32 v235, v125, v121, s72
    v_mfma_f32_16x16x32_bf16 v[196:199], v[228:231], v[244:247], v[196:199]
    v_perm_b32 v236, v101, v97, s73
    v_perm_b32 v237, v109, v105, s73
    v_perm_b32 v238, v117, v113, s73
    v_perm_b32 v239, v125, v121, s73
    v_mfma_f32_16x16x32_bf16 v[200:203], v[232:235], v[244:247], v[200:203]
    v_perm_b32 v224, v102, v98, s72
    v_perm_b32 v225, v110, v106, s72
    v_perm_b32 v226, v118, v114, s72
    v_perm_b32 v227, v126, v122, s72
    v_mfma_f32_16x16x32_bf16 v[204:207], v[236:239], v[244:247], v[204:207]
    v_perm_b32 v228, v102, v98, s73
    v_perm_b32 v229, v110, v106, s73
    v_perm_b32 v230, v118, v114, s73
    v_perm_b32 v231, v126, v122, s73
    v_mfma_f32_16x16x32_bf16 v[208:211], v[224:227], v[244:247], v[208:211]
    v_perm_b32 v232, v103, v99, s72
    v_perm_b32 v233, v111, v107, s72
    v_perm_b32 v234, v119, v115, s72
    v_perm_b32 v235, v127, v123, s72
    v_mfma_f32_16x16x32_bf16 v[212:215], v[228:231], v[244:247], v[212:215]
    v_perm_b32 v236, v103, v99, s73
    v_perm_b32 v237, v111, v107, s73
    v_perm_b32 v238, v119, v115, s73
    v_perm_b32 v239, v127, v123, s73
    v_mfma_f32_16x16x32_bf16 v[216:219], v[232:235], v[244:247], v[216:219]
    s_nop 0
    v_mfma_f32_16x16x32_bf16 v[220:223], v[236:239], v[244:247], v[220:223]
    s_add_u32 s6, s4, 0xc00000
    s_waitcnt vmcnt(3)
    buffer_load_dwordx4 v[160:163], v5, s[36:39], s6 offen nt
    s_add_u32 s6, s4, 0xc80000
    s_waitcnt vmcnt(3)
    buffer_load_dwordx4 v[164:167], v5, s[36:39], s6 offen nt
    s_add_u32 s6, s4, 0xd00000
    s_waitcnt vmcnt(3)
    buffer_load_dwordx4 v[168:171], v5, s[36:39], s6 offen nt
    s_add_u32 s6, s4, 0xd80000
    s_waitcnt vmcnt(3)
    buffer_load_dwordx4 v[172:175], v5, s[36:39], s6 offen nt
    s_add_u32 s6, s4, 0xe00000
    s_waitcnt vmcnt(3)
    buffer_load_dwordx4 v[176:179], v5, s[36:39], s6 offen nt
    s_add_u32 s6, s4, 0xe80000
    s_waitcnt vmcnt(3)
    buffer_load_dwordx4 v[180:183], v5, s[36:39], s6 offen nt
    s_add_u32 s6, s4, 0xf00000
    s_waitcnt vmcnt(3)
    buffer_load_dwordx4 v[184:187], v5, s[36:39], s6 offen nt
    s_add_u32 s6, s4, 0xf80000
    s_waitcnt vmcnt(3)
    buffer_load_dwordx4 v[188:191], v5, s[36:39], s6 offen nt
    v_max_u32 v7, v48, v49
    v_max3_u32 v7, v7, v50, v51
    v_cmp_eq_u32 vcc, -1, v7
    s_nop 1
    s_cbranch_vccz L_hok_7
    s_nop 1
L_poll_8:
    buffer_load_dwordx4 v[48:51], v11, s[56:59], s90 offen sc1
    s_waitcnt vmcnt(0)
    v_max_u32 v7, v48, v49
    v_max3_u32 v7, v7, v50, v51
    v_cmp_eq_u32 vcc, -1, v7
    s_nop 1
    s_cbranch_vccz L_polld_9
    s_add_u32 s7, s7, 1
    s_cmp_ge_u32 s7, 200000
    s_cbranch_scc1 L_polld_9
    s_sleep 1
    s_branch L_poll_8
L_polld_9:
L_hok_7:
    v_add_f32_dpp v48, v48, v48 quad_perm:[1,0,3,2] row_mask:0xf bank_mask:0xf
    v_add_f32_dpp v49, v49, v49 quad_perm:[1,0,3,2] row_mask:0xf bank_mask:0xf
    v_add_f32_dpp v50, v50, v50 quad_perm:[1,0,3,2] row_mask:0xf bank_mask:0xf
    v_add_f32_dpp v51, v51, v51 quad_perm:[1,0,3,2] row_mask:0xf bank_mask:0xf
    v_add_f32_dpp v48, v48, v48 quad_perm:[2,3,0,1] row_mask:0xf bank_mask:0xf
    v_add_f32_dpp v49, v49, v49 quad_perm:[2,3,0,1] row_mask:0xf bank_mask:0xf
    v_add_f32_dpp v50, v50, v50 quad_perm:[2,3,0,1] row_mask:0xf bank_mask:0xf
    v_add_f32_dpp v51, v51, v51 quad_perm:[2,3,0,1] row_mask:0xf bank_mask:0xf
    v_mov_b32_dpp v56, v48 row_ror:4 row_mask:0xf bank_mask:0xf
    v_mov_b32_dpp v57, v49 row_ror:4 row_mask:0xf bank_mask:0xf
    v_mov_b32_dpp v58, v50 row_ror:4 row_mask:0xf bank_mask:0xf
    v_mov_b32_dpp v59, v51 row_ror:4 row_mask:0xf bank_mask:0xf
    v_cvt_pk_bf16_f32 v6, v48, v49
    v_lshlrev_b32 v48, 16, v6
    v_and_b32 v49, 0xffff0000, v6
    v_cvt_pk_bf16_f32 v6, v56, v57
    v_lshlrev_b32 v56, 16, v6
    v_and_b32 v57, 0xffff0000, v6
    v_cvt_pk_bf16_f32 v6, v50, v51
    v_lshlrev_b32 v50, 16, v6
    v_and_b32 v51, 0xffff0000, v6
    v_cvt_pk_bf16_f32 v6, v58, v59
    v_lshlrev_b32 v58, 16, v6
    v_and_b32 v59, 0xffff0000, v6
    v_mul_f32 v52, v48, v48
    v_mul_f32 v52, v52, v48
    v_mul_f32 v52, 0x3d372713, v52
    v_add_f32 v52, v52, v48
    v_mul_f32 v52, 0xc0135761, v52
    v_exp_f32 v52, v52
    s_nop 0
    v_add_f32 v52, 1.0, v52
    v_rcp_f32 v52, v52
    s_nop 0
    v_mul_f32 v48, v48, v52
    v_mul_f32 v53, v49, v49
    v_mul_f32 v53, v53, v49
    v_mul_f32 v53, 0x3d372713, v53
    v_add_f32 v53, v53, v49
    v_mul_f32 v53, 0xc0135761, v53
    v_exp_f32 v53, v53
    s_nop 0
    v_add_f32 v53, 1.0, v53
    v_rcp_f32 v53, v53
    s_nop 0
    v_mul_f32 v49, v49, v53
    v_mul_f32 v54, v50, v50
    v_mul_f32 v54, v54, v50
    v_mul_f32 v54, 0x3d372713, v54
    v_add_f32 v54, v54, v50
    v_mul_f32 v54, 0xc0135761, v54
    v_exp_f32 v54, v54
    s_nop 0
    v_add_f32 v54, 1.0, v54
    v_rcp_f32 v54, v54
    s_nop 0
    v_mul_f32 v50, v50, v54
    v_mul_f32 v55, v51, v51
    v_mul_f32 v55, v55, v51
    v_mul_f32 v55, 0x3d372713, v55
    v_add_f32 v55, v55, v51
    v_mul_f32 v55, 0xc0135761, v55
    v_exp_f32 v55, v55
    s_nop 0
    v_add_f32 v55, 1.0, v55
    v_rcp_f32 v55, v55
    s_nop 0
    v_mul_f32 v51, v51, v55
    v_cvt_pk_bf16_f32 v6, v48, v49
    v_lshlrev_b32 v48, 16, v6
    v_and_b32 v49, 0xffff0000, v6
    v_cvt_pk_bf16_f32 v6, v50, v51
    v_lshlrev_b32 v50, 16, v6
    v_and_b32 v51, 0xffff0000, v6
    v_mul_f32 v48, v48, v56
    v_mul_f32 v49, v49, v57
    v_mul_f32 v50, v50, v58
    v_mul_f32 v51, v51, v59
    v_cvt_pk_bf16_f32 v226, v48, v49
    v_cvt_pk_bf16_f32 v227, v50, v51
    v_perm_b32 v224, v36, v32, s72
    v_perm_b32 v225, v44, v40, s72
    v_perm_b32 v228, v36, v32, s73
    v_perm_b32 v229, v44, v40, s73
    v_perm_b32 v232, v37, v33, s72
    v_perm_b32 v233, v45, v41, s72
    v_mfma_f32_16x16x16_bf16 v[48:51], v[226:227], v[224:225], 0
    v_perm_b32 v236, v37, v33, s73
    v_perm_b32 v237, v45, v41, s73
    v_mfma_f32_16x16x16_bf16 v[52:55], v[226:227], v[228:229], 0
    v_perm_b32 v224, v38, v34, s72
    v_perm_b32 v225, v46, v42, s72
    v_mfma_f32_16x16x16_bf16 v[56:59], v[226:227], v[232:233], 0
    v_perm_b32 v228, v38, v34, s73
    v_perm_b32 v229, v46, v42, s73
    v_mfma_f32_16x16x16_bf16 v[60:63], v[226:227], v[236:237], 0
    v_perm_b32 v232, v39, v35, s72
    v_perm_b32 v233, v47, v43, s72
    v_mov_b32 v24, v48
    v_mfma_f32_16x16x16_bf16 v[48:51], v[226:227], v[224:225], 0
    v_perm_b32 v236, v39, v35, s73
    v_perm_b32 v237, v47, v43, s73
    v_mov_b32 v25, v52
    v_mfma_f32_16x16x16_bf16 v[52:55], v[226:227], v[228:229], 0
    v_mov_b32 v26, v56
    v_mfma_f32_16x16x16_bf16 v[56:59], v[226:227], v[232:233], 0
    v_mov_b32 v27, v60
    v_mfma_f32_16x16x16_bf16 v[60:63], v[226:227], v[236:237], 0
    v_mov_b32 v28, v48
    s_nop 2
    v_mov_b32 v29, v52
    s_nop 0
    v_mov_b32 v30, v56
    s_nop 0
    v_mov_b32 v31, v60
    v_perm_b32 v224, v132, v128, s72
    v_perm_b32 v225, v140, v136, s72
    v_perm_b32 v226, v148, v144, s72
    v_perm_b32 v227, v156, v152, s72
    v_perm_b32 v228, v132, v128, s73
    v_perm_b32 v229, v140, v136, s73
    v_perm_b32 v230, v148, v144, s73
    v_perm_b32 v231, v156, v152, s73
    v_mfma_f32_16x16x32_bf16 v[192:195], v[224:227], v[248:251], v[192:195]
    v_perm_b32 v232, v133, v129, s72
    v_perm_b32 v233, v141, v137, s72
    v_perm_b32 v234, v149, v145, s72
    v_perm_b32 v235, v157, v153, s72
    v_mfma_f32_16x16x32_bf16 v[196:199], v[228:231], v[248:251], v[196:199]
    v_perm_b32 v236, v133, v129, s73
    v_perm_b32 v237, v141, v137, s73
    v_perm_b32 v238, v149, v145, s73
    v_perm_b32 v239, v157, v153, s73
    v_mfma_f32_16x16x32_bf16 v[200:203], v[232:235], v[248:251], v[200:203]
    v_perm_b32 v224, v134, v130, s72
    v_perm_b32 v225, v142, v138, s72
    v_perm_b32 v226, v150, v146, s72
    v_perm_b32 v227, v158, v154, s72
    v_mfma_f32_16x16x32_bf16 v[204:207], v[236:239], v[248:251], v[204:207]
    v_perm_b32 v228, v134, v130, s73
    v_perm_b32 v229, v142, v138, s73
    v_perm_b32 v230, v150, v146, s73
    v_perm_b32 v231, v158, v154, s73
    v_mfma_f32_16x16x32_bf16 v[208:211], v[224:227], v[248:251], v[208:211]
    v_perm_b32 v232, v135, v131, s72
    v_perm_b32 v233, v143, v139, s72
    v_perm_b32 v234, v151, v147, s72
    v_perm_b32 v235, v159, v155, s72
    v_mfma_f32_16x16x32_bf16 v[212:215], v[228:231], v[248:251], v[212:215]
    v_perm_b32 v236, v135, v131, s73
    v_perm_b32 v237, v143, v139, s73
    v_perm_b32 v238, v151, v147, s73
    v_perm_b32 v239, v159, v155, s73
    v_mfma_f32_16x16x32_bf16 v[216:219], v[232:235], v[248:251], v[216:219]
    s_nop 0
    v_mfma_f32_16x16x32_bf16 v[220:223], v[236:239], v[248:251], v[220:223]
    s_waitcnt vmcnt(0)
    v_lshlrev_b32 v9, 11, v3
    v_lshl_add_u32 v9, v2, 4, v9
    s_lshl_b32 s80, s76, 7
    s_lshr_b32 s81, s3, 1
    s_lshl_b32 s81, s81, 5
    s_add_u32 s80, s80, s81
    s_and_b32 s81, s3, 1
    s_lshl_b32 s81, s81, 2
    s_add_u32 s80, s80, s81
    s_lshl_b32 s80, s80, 11
    s_lshl_b32 s81, s77, 8
    s_add_u32 s80, s80, s81
    s_add_u32 s5, s80, 0
    buffer_load_dwordx4 v[96:99], v9, s[44:47], s5 offen nt
    s_add_u32 s5, s80, 16384
    buffer_load_dwordx4 v[100:103], v9, s[44:47], s5 offen nt
    s_add_u32 s5, s80, 32768
    buffer_load_dwordx4 v[104:107], v9, s[44:47], s5 offen nt
    s_add_u32 s5, s80, 49152
    buffer_load_dwordx4 v[108:111], v9, s[44:47], s5 offen nt
    v_perm_b32 v224, v164, v160, s72
    v_perm_b32 v225, v172, v168, s72
    v_perm_b32 v226, v180, v176, s72
    v_perm_b32 v227, v188, v184, s72
    v_perm_b32 v228, v164, v160, s73
    v_perm_b32 v229, v172, v168, s73
    v_perm_b32 v230, v180, v176, s73
    v_perm_b32 v231, v188, v184, s73
    v_mfma_f32_16x16x32_bf16 v[192:195], v[224:227], v[252:255], v[192:195]
    v_perm_b32 v232, v165, v161, s72
    v_perm_b32 v233, v173, v169, s72
    v_perm_b32 v234, v181, v177, s72
    v_perm_b32 v235, v189, v185, s72
    v_mfma_f32_16x16x32_bf16 v[196:199], v[228:231], v[252:255], v[196:199]
    v_perm_b32 v236, v165, v161, s73
    v_perm_b32 v237, v173, v169, s73
    v_perm_b32 v238, v181, v177, s73
    v_perm_b32 v239, v189, v185, s73
    v_mfma_f32_16x16x32_bf16 v[200:203], v[232:235], v[252:255], v[200:203]
    v_perm_b32 v224, v166, v162, s72
    v_perm_b32 v225, v174, v170, s72
    v_perm_b32 v226, v182, v178, s72
    v_perm_b32 v227, v190, v186, s72
    v_mfma_f32_16x16x32_bf16 v[204:207], v[236:239], v[252:255], v[204:207]
    v_perm_b32 v228, v166, v162, s73
    v_perm_b32 v229, v174, v170, s73
    v_perm_b32 v230, v182, v178, s73
    v_perm_b32 v231, v190, v186, s73
    v_mfma_f32_16x16x32_bf16 v[208:211], v[224:227], v[252:255], v[208:211]
    v_perm_b32 v232, v167, v163, s72
    v_perm_b32 v233, v175, v171, s72
    v_perm_b32 v234, v183, v179, s72
    v_perm_b32 v235, v191, v187, s72
    v_mfma_f32_16x16x32_bf16 v[212:215], v[228:231], v[252:255], v[212:215]
    v_perm_b32 v236, v167, v163, s73
    v_perm_b32 v237, v175, v171, s73
    v_perm_b32 v238, v183, v179, s73
    v_perm_b32 v239, v191, v187, s73
    v_mfma_f32_16x16x32_bf16 v[216:219], v[232:235], v[252:255], v[216:219]
    s_nop 0
    v_mfma_f32_16x16x32_bf16 v[220:223], v[236:239], v[252:255], v[220:223]
    s_mul_i32 s80, s3, 4224
    v_mul_u32_u24 v6, 528, v2
    v_lshl_add_u32 v6, v3, 7, v6
    v_add_u32 v6, s80, v6
    s_mov_b32 s86, 0x00ff00ff
    s_mov_b32 s87, 0x00ff00ff
    s_mov_b64 exec, s[86:87]
    ds_write_b128 v6, v[192:195] offset:8192
    ds_write_b128 v6, v[196:199] offset:8208
    ds_write_b128 v6, v[200:203] offset:8224
    ds_write_b128 v6, v[204:207] offset:8240
    ds_write_b128 v6, v[208:211] offset:8256
    ds_write_b128 v6, v[212:215] offset:8272
    ds_write_b128 v6, v[216:219] offset:8288
    ds_write_b128 v6, v[220:223] offset:8304
    s_mov_b64 exec, 0xff
    s_lshl_b32 s80, s3, 6
    v_lshlrev_b32 v7, 3, v0
    v_add_u32 v7, s80, v7
    ds_write_b64 v7, v[14:15] offset:41984
    s_mov_b64 exec, -1
    s_waitcnt lgkmcnt(0)
    s_barrier
    s_mul_i32 s80, s3, 528
    v_lshlrev_b32 v6, 3, v0
    v_add_u32 v7, s80, v6
    s_lshl_b32 s80, s3, 3
    v_mov_b32 v6, s80
    ds_read_b64 v[208:209], v6 offset:41984
    ds_read_b64 v[210:211], v6 offset:42048
    ds_read_b64 v[212:213], v6 offset:42112
    ds_read_b64 v[214:215], v6 offset:42176
    ds_read_b64 v[216:217], v6 offset:42240
    ds_read_b64 v[218:219], v6 offset:42304
    ds_read_b64 v[220:221], v6 offset:42368
    ds_read_b64 v[222:223], v6 offset:42432
    ds_read_b64 v[192:193], v7 offset:8192
    ds_read_b64 v[194:195], v7 offset:12416
    ds_read_b64 v[196:197], v7 offset:16640
    ds_read_b64 v[198:199], v7 offset:20864
    ds_read_b64 v[200:201], v7 offset:25088
    ds_read_b64 v[202:203], v7 offset:29312
    ds_read_b64 v[204:205], v7 offset:33536
    ds_read_b64 v[206:207], v7 offset:37760
    s_waitcnt lgkmcnt(0)
    v_max3_f32 v14, v208, v210, v212
    v_max3_f32 v14, v14, v214, v216
    v_max3_f32 v14, v14, v218, v220
    v_max_f32 v14, v14, v222
    v_sub_f32 v208, v208, v14
    v_mul_f32 v208, s75, v208
    v_exp_f32 v208, v208
    v_sub_f32 v210, v210, v14
    v_mul_f32 v210, s75, v210
    v_exp_f32 v210, v210
    v_sub_f32 v212, v212, v14
    v_mul_f32 v212, s75, v212
    v_exp_f32 v212, v212
    v_sub_f32 v214, v214, v14
    v_mul_f32 v214, s75, v214
    v_exp_f32 v214, v214
    v_sub_f32 v216, v216, v14
    v_mul_f32 v216, s75, v216
    v_exp_f32 v216, v216
    v_sub_f32 v218, v218, v14
    v_mul_f32 v218, s75, v218
    v_exp_f32 v218, v218
    v_sub_f32 v220, v220, v14
    v_mul_f32 v220, s75, v220
    v_exp_f32 v220, v220
    v_sub_f32 v222, v222, v14
    v_mul_f32 v222, s75, v222
    v_exp_f32 v222, v222
    v_mul_f32 v240, v208, v192
    v_mul_f32 v241, v208, v193
    v_mul_f32 v15, v208, v209
    v_fmac_f32 v240, v210, v194
    v_fmac_f32 v241, v210, v195
    v_fmac_f32 v15, v210, v211
    v_fmac_f32 v240, v212, v196
    v_fmac_f32 v241, v212, v197
    v_fmac_f32 v15, v212, v213
    v_fmac_f32 v240, v214, v198
    v_fmac_f32 v241, v214, v199
    v_fmac_f32 v15, v214, v215
    v_fmac_f32 v240, v216, v200
    v_fmac_f32 v241, v216, v201
    v_fmac_f32 v15, v216, v217
    v_fmac_f32 v240, v218, v202
    v_fmac_f32 v241, v218, v203
    v_fmac_f32 v15, v218, v219
    v_fmac_f32 v240, v220, v204
    v_fmac_f32 v241, v220, v205
    v_fmac_f32 v15, v220, v221
    v_fmac_f32 v240, v222, v206
    v_fmac_f32 v241, v222, v207
    v_fmac_f32 v15, v222, v223
    v_lshrrev_b32 v6, 3, v0
    v_lshlrev_b32 v6, 12, v6
    v_and_b32 v7, 7, v0
    v_lshl_add_u32 v6, v7, 3, v6
    s_lshl_b32 s80, s78, 18
    s_lshl_b32 s81, s3, 15
    s_add_u32 s80, s80, s81
    s_and_b32 s82, s2, 63
    s_lshl_b32 s81, s82, 6
    s_add_u32 s80, s80, s81
    s_add_u32 s80, s80, 0x100000
    buffer_store_dwordx2 v[240:241], v6, s[56:59], s80 offen sc1
    s_lshl_b32 s80, s78, 12
    s_lshl_b32 s81, s3, 9
    s_add_u32 s80, s80, s81
    s_lshl_b32 s81, s82, 3
    s_add_u32 s80, s80, s81
    s_add_u32 s80, s80, 0x200000
    s_mov_b64 exec, 1
    buffer_store_dwordx2 v[14:15], v12, s[56:59], s80 offen sc1
    s_mov_b64 exec, -1
    s_lshl_b32 s85, s76, 9
    s_add_u32 s85, s85, 0x200000
    s_barrier
    v_lshlrev_b32 v6, 3, v2
    v_lshlrev_b32 v8, 6, v2
    v_lshl_add_u32 v8, v3, 4, v8
    s_lshl_b32 s83, s76, 15
    s_lshl_b32 s81, s3, 12
    s_add_u32 s83, s83, s81
    s_add_u32 s83, s83, 0x100000
L_poll_10:
    buffer_load_dwordx2 v[160:161], v6, s[56:59], s85 offen offset:0 sc1
    buffer_load_dwordx2 v[162:163], v6, s[56:59], s85 offen offset:128 sc1
    buffer_load_dwordx2 v[164:165], v6, s[56:59], s85 offen offset:256 sc1
    buffer_load_dwordx2 v[166:167], v6, s[56:59], s85 offen offset:384 sc1
    buffer_load_dwordx4 v[168:171], v8, s[56:59], s83 offen offset:0 sc1
    buffer_load_dwordx4 v[172:175], v8, s[56:59], s83 offen offset:1024 sc1
    buffer_load_dwordx4 v[176:179], v8, s[56:59], s83 offen offset:2048 sc1
    buffer_load_dwordx4 v[180:183], v8, s[56:59], s83 offen offset:3072 sc1
    s_waitcnt vmcnt(0)
    v_max_u32 v7, v160, v161
    v_max3_u32 v7, v7, v162, v163
    v_max3_u32 v7, v7, v164, v165
    v_max3_u32 v7, v7, v166, v167
    v_max3_u32 v7, v7, v168, v169
    v_max3_u32 v7, v7, v170, v171
    v_max3_u32 v7, v7, v172, v173
    v_max3_u32 v7, v7, v174, v175
    v_max3_u32 v7, v7, v176, v177
    v_max3_u32 v7, v7, v178, v179
    v_max3_u32 v7, v7, v180, v181
    v_max3_u32 v7, v7, v182, v183
    v_cmp_eq_u32 vcc, -1, v7
    s_nop 1
    s_cbranch_vccz L_polld_11
    s_add_u32 s7, s7, 1
    s_cmp_ge_u32 s7, 200000
    s_cbranch_scc1 L_polld_11
    s_sleep 1
    s_branch L_poll_10
L_polld_11:
    v_max3_f32 v14, v160, v162, v164
    v_max_f32 v14, v14, v166
    s_nop 1
    v_max_f32_dpp v14, v14, v14 row_ror:1 row_mask:0xf bank_mask:0xf
    s_nop 1
    v_max_f32_dpp v14, v14, v14 row_ror:2 row_mask:0xf bank_mask:0xf
    s_nop 1
    v_max_f32_dpp v14, v14, v14 row_ror:4 row_mask:0xf bank_mask:0xf
    s_nop 1
    v_max_f32_dpp v14, v14, v14 row_ror:8 row_mask:0xf bank_mask:0xf
    v_sub_f32 v160, v160, v14
    v_mul_f32 v160, s75, v160
    v_exp_f32 v160, v160
    v_sub_f32 v162, v162, v14
    v_mul_f32 v162, s75, v162
    v_exp_f32 v162, v162
    v_sub_f32 v164, v164, v14
    v_mul_f32 v164, s75, v164
    v_exp_f32 v164, v164
    v_sub_f32 v166, v166, v14
    v_mul_f32 v166, s75, v166
    v_exp_f32 v166, v166
    v_mul_f32 v15, v160, v161
    v_mul_f32 v16, v160, v168
    v_mul_f32 v17, v160, v169
    v_mul_f32 v18, v160, v170
    v_mul_f32 v19, v160, v171
    v_fmac_f32 v15, v162, v163
    v_fmac_f32 v16, v162, v172
    v_fmac_f32 v17, v162, v173
    v_fmac_f32 v18, v162, v174
    v_fmac_f32 v19, v162, v175
    v_fmac_f32 v15, v164, v165
    v_fmac_f32 v16, v164, v176
    v_fmac_f32 v17, v164, v177
    v_fmac_f32 v18, v164, v178
    v_fmac_f32 v19, v164, v179
    v_fmac_f32 v15, v166, v167
    v_fmac_f32 v16, v166, v180
    v_fmac_f32 v17, v166, v181
    v_fmac_f32 v18, v166, v182
    v_fmac_f32 v19, v166, v183
    v_add_f32_dpp v15, v15, v15 row_ror:1 row_mask:0xf bank_mask:0xf
    v_add_f32_dpp v16, v16, v16 row_ror:1 row_mask:0xf bank_mask:0xf
    v_add_f32_dpp v17, v17, v17 row_ror:1 row_mask:0xf bank_mask:0xf
    v_add_f32_dpp v18, v18, v18 row_ror:1 row_mask:0xf bank_mask:0xf
    v_add_f32_dpp v19, v19, v19 row_ror:1 row_mask:0xf bank_mask:0xf
    v_add_f32_dpp v15, v15, v15 row_ror:2 row_mask:0xf bank_mask:0xf
    v_add_f32_dpp v16, v16, v16 row_ror:2 row_mask:0xf bank_mask:0xf
    v_add_f32_dpp v17, v17, v17 row_ror:2 row_mask:0xf bank_mask:0xf
    v_add_f32_dpp v18, v18, v18 row_ror:2 row_mask:0xf bank_mask:0xf
    v_add_f32_dpp v19, v19, v19 row_ror:2 row_mask:0xf bank_mask:0xf
    v_add_f32_dpp v15, v15, v15 row_ror:4 row_mask:0xf bank_mask:0xf
    v_add_f32_dpp v16, v16, v16 row_ror:4 row_mask:0xf bank_mask:0xf
    v_add_f32_dpp v17, v17, v17 row_ror:4 row_mask:0xf bank_mask:0xf
    v_add_f32_dpp v18, v18, v18 row_ror:4 row_mask:0xf bank_mask:0xf
    v_add_f32_dpp v19, v19, v19 row_ror:4 row_mask:0xf bank_mask:0xf
    v_add_f32_dpp v15, v15, v15 row_ror:8 row_mask:0xf bank_mask:0xf
    v_add_f32_dpp v16, v16, v16 row_ror:8 row_mask:0xf bank_mask:0xf
    v_add_f32_dpp v17, v17, v17 row_ror:8 row_mask:0xf bank_mask:0xf
    v_add_f32_dpp v18, v18, v18 row_ror:8 row_mask:0xf bank_mask:0xf
    v_add_f32_dpp v19, v19, v19 row_ror:8 row_mask:0xf bank_mask:0xf
    v_rcp_f32 v6, v15
    s_nop 0
    v_mul_f32 v7, v16, v6
    v_fma_f32 v8, -v7, v15, v16
    v_fma_f32 v16, v8, v6, v7
    v_mul_f32 v7, v17, v6
    v_fma_f32 v8, -v7, v15, v17
    v_fma_f32 v17, v8, v6, v7
    v_mul_f32 v7, v18, v6
    v_fma_f32 v8, -v7, v15, v18
    v_fma_f32 v18, v8, v6, v7
    v_mul_f32 v7, v19, v6
    v_fma_f32 v8, -v7, v15, v19
    v_fma_f32 v19, v8, v6, v7
    v_cvt_pk_bf16_f32 v20, v16, v17
    v_cvt_pk_bf16_f32 v21, v18, v19
    v_perm_b32 v224, v100, v96, s72
    v_perm_b32 v225, v108, v104, s72
    v_perm_b32 v228, v100, v96, s73
    v_perm_b32 v229, v108, v104, s73
    v_perm_b32 v232, v101, v97, s72
    v_perm_b32 v233, v109, v105, s72
    v_mfma_f32_16x16x16_bf16 v[192:195], v[20:21], v[224:225], 0
    v_perm_b32 v236, v101, v97, s73
    v_perm_b32 v237, v109, v105, s73
    v_mfma_f32_16x16x16_bf16 v[196:199], v[20:21], v[228:229], 0
    v_perm_b32 v224, v102, v98, s72
    v_perm_b32 v225, v110, v106, s72
    v_mfma_f32_16x16x16_bf16 v[200:203], v[20:21], v[232:233], 0
    v_perm_b32 v228, v102, v98, s73
    v_perm_b32 v229, v110, v106, s73
    v_mfma_f32_16x16x16_bf16 v[204:207], v[20:21], v[236:237], 0
    v_perm_b32 v232, v103, v99, s72
    v_perm_b32 v233, v111, v107, s72
    v_mov_b32 v64, v192
    v_mfma_f32_16x16x16_bf16 v[192:195], v[20:21], v[224:225], 0
    v_perm_b32 v236, v103, v99, s73
    v_perm_b32 v237, v111, v107, s73
    v_mov_b32 v65, v196
    v_mfma_f32_16x16x16_bf16 v[196:199], v[20:21], v[228:229], 0
    v_mov_b32 v66, v200
    v_mfma_f32_16x16x16_bf16 v[200:203], v[20:21], v[232:233], 0
    v_mov_b32 v67, v204
    v_mfma_f32_16x16x16_bf16 v[204:207], v[20:21], v[236:237], 0
    v_mov_b32 v68, v192
    s_nop 2
    v_mov_b32 v69, v196
    s_nop 0
    v_mov_b32 v70, v200
    s_nop 0
    v_mov_b32 v71, v204
    v_mov_b32 v72, v24
    v_mov_b32 v73, v25
    v_mov_b32 v74, v26
    v_mov_b32 v75, v27
    v_mov_b32 v76, v28
    v_mov_b32 v77, v29
    v_mov_b32 v78, v30
    v_mov_b32 v79, v31
    s_lshl_b32 s80, s3, 10
    v_lshlrev_b32 v6, 5, v2
    v_add_u32 v6, s80, v6
    s_mov_b64 exec, 0xffff
    ds_write_b128 v6, v[64:67] offset:42496
    ds_write_b128 v6, v[68:71] offset:42512
    ds_write_b128 v6, v[72:75] offset:43008
    ds_write_b128 v6, v[76:79] offset:43024
    s_mov_b64 exec, -1
    s_waitcnt lgkmcnt(0)
    s_barrier
    s_endpgm
L_wave0:
    v_lshlrev_b32 v6, 5, v0
    buffer_load_dwordx4 v[16:19], v6, s[60:63], 0 offen
    buffer_load_dwordx4 v[20:23], v6, s[60:63], 0 offen offset:16
    s_cmp_lg_u32 s2, 0
    s_cbranch_scc1 L_nonce_12
    s_memrealtime s[98:99]
    s_waitcnt lgkmcnt(0)
    s_or_b32 s98, s98, 1
    v_mov_b32 v28, s98
    v_mov_b32 v29, s99
    s_mov_b64 exec, 1
    buffer_store_dwordx2 v[28:29], v12, s[68:71], 0 offen offset:8 sc1
    s_mov_b64 exec, -1
    s_waitcnt vmcnt(0)
L_nonce_12:
    v_lshlrev_b32 v7, 16, v3
    v_lshl_add_u32 v7, v2, 4, v7
    s_lshl_b32 s80, s77, 20
    s_lshl_b32 s81, s76, 8
    s_add_u32 s80, s80, s81
    s_add_u32 s5, s80, 0x0
    buffer_load_dwordx4 v[128:131], v7, s[40:43], s5 offen nt
    s_add_u32 s5, s80, 0x2000
    buffer_load_dwordx4 v[132:135], v7, s[40:43], s5 offen nt
    s_add_u32 s5, s80, 0x4000
    buffer_load_dwordx4 v[136:139], v7, s[40:43], s5 offen nt
    s_add_u32 s5, s80, 0x6000
    buffer_load_dwordx4 v[140:143], v7, s[40:43], s5 offen nt
    s_add_u32 s5, s80, 0x8000
    buffer_load_dwordx4 v[144:147], v7, s[40:43], s5 offen nt
    s_add_u32 s5, s80, 0xa000
    buffer_load_dwordx4 v[148:151], v7, s[40:43], s5 offen nt
    s_add_u32 s5, s80, 0xc000
    buffer_load_dwordx4 v[152:155], v7, s[40:43], s5 offen nt
    s_add_u32 s5, s80, 0xe000
    buffer_load_dwordx4 v[156:159], v7, s[40:43], s5 offen nt
    s_add_u32 s5, s80, 0x40000
    buffer_load_dwordx4 v[160:163], v7, s[40:43], s5 offen nt
    s_add_u32 s5, s80, 0x42000
    buffer_load_dwordx4 v[164:167], v7, s[40:43], s5 offen nt
    s_add_u32 s5, s80, 0x44000
    buffer_load_dwordx4 v[168:171], v7, s[40:43], s5 offen nt
    s_add_u32 s5, s80, 0x46000
    buffer_load_dwordx4 v[172:175], v7, s[40:43], s5 offen nt
    s_add_u32 s5, s80, 0x48000
    buffer_load_dwordx4 v[176:179], v7, s[40:43], s5 offen nt
    s_add_u32 s5, s80, 0x4a000
    buffer_load_dwordx4 v[180:183], v7, s[40:43], s5 offen nt
    s_add_u32 s5, s80, 0x4c000
    s_waitcnt vmcnt(15)
    buffer_load_dwordx4 v[184:187], v7, s[40:43], s5 offen nt
    s_add_u32 s5, s80, 0x4e000
    s_waitcnt vmcnt(15)
    buffer_load_dwordx4 v[188:191], v7, s[40:43], s5 offen nt
    s_add_u32 s5, s80, 0x80000
    s_waitcnt vmcnt(15)
    buffer_load_dwordx4 v[192:195], v7, s[40:43], s5 offen nt
    s_add_u32 s5, s80, 0x82000
    s_waitcnt vmcnt(15)
    buffer_load_dwordx4 v[196:199], v7, s[40:43], s5 offen nt
    s_add_u32 s5, s80, 0x84000
    s_waitcnt vmcnt(15)
    buffer_load_dwordx4 v[200:203], v7, s[40:43], s5 offen nt
    s_add_u32 s5, s80, 0x86000
    s_waitcnt vmcnt(15)
    buffer_load_dwordx4 v[204:207], v7, s[40:43], s5 offen nt
    s_add_u32 s5, s80, 0x88000
    s_waitcnt vmcnt(15)
    buffer_load_dwordx4 v[208:211], v7, s[40:43], s5 offen nt
    s_add_u32 s5, s80, 0x8a000
    s_waitcnt vmcnt(15)
    buffer_load_dwordx4 v[212:215], v7, s[40:43], s5 offen nt
    s_add_u32 s5, s80, 0x8c000
    s_waitcnt vmcnt(15)
    buffer_load_dwordx4 v[216:219], v7, s[40:43], s5 offen nt
    s_add_u32 s5, s80, 0x8e000
    s_waitcnt vmcnt(15)
    buffer_load_dwordx4 v[220:223], v7, s[40:43], s5 offen nt
    s_add_u32 s5, s80, 0xc0000
    s_waitcnt vmcnt(15)
    buffer_load_dwordx4 v[224:227], v7, s[40:43], s5 offen nt
    s_add_u32 s5, s80, 0xc2000
    s_waitcnt vmcnt(15)
    buffer_load_dwordx4 v[228:231], v7, s[40:43], s5 offen nt
    s_add_u32 s5, s80, 0xc4000
    s_waitcnt vmcnt(15)
    buffer_load_dwordx4 v[232:235], v7, s[40:43], s5 offen nt
    s_add_u32 s5, s80, 0xc6000
    s_waitcnt vmcnt(15)
    buffer_load_dwordx4 v[236:239], v7, s[40:43], s5 offen nt
    s_add_u32 s5, s80, 0xc8000
    s_waitcnt vmcnt(15)
    buffer_load_dwordx4 v[240:243], v7, s[40:43], s5 offen nt
    s_add_u32 s5, s80, 0xca000
    s_waitcnt vmcnt(15)
    buffer_load_dwordx4 v[244:247], v7, s[40:43], s5 offen nt
    s_add_u32 s5, s80, 0xcc000
    s_waitcnt vmcnt(15)
    buffer_load_dwordx4 v[248:251], v7, s[40:43], s5 offen nt
    s_add_u32 s5, s80, 0xce000
    s_waitcnt vmcnt(15)
    buffer_load_dwordx4 v[252:255], v7, s[40:43], s5 offen nt
    s_mov_b32 s80, 57344
    v_mul_lo_u32 v8, v3, s80
    v_lshl_add_u32 v8, v2, 4, v8
    s_add_u32 s5, s94, 0
    s_waitcnt vmcnt(15)
    buffer_load_dwordx4 v[96:99], v8, s[48:51], s5 offen nt
    s_add_u32 s5, s94, 7168
    s_waitcnt vmcnt(15)
    buffer_load_dwordx4 v[100:103], v8, s[48:51], s5 offen nt
    s_add_u32 s5, s94, 14336
    s_waitcnt vmcnt(15)
    buffer_load_dwordx4 v[104:107], v8, s[48:51], s5 offen nt
    s_add_u32 s5, s94, 21504
    s_waitcnt vmcnt(15)
    buffer_load_dwordx4 v[108:111], v8, s[48:51], s5 offen nt
    s_add_u32 s5, s94, 28672
    s_waitcnt vmcnt(15)
    buffer_load_dwordx4 v[112:115], v8, s[48:51], s5 offen nt
    s_add_u32 s5, s94, 35840
    s_waitcnt vmcnt(15)
    buffer_load_dwordx4 v[116:119], v8, s[48:51], s5 offen nt
    s_add_u32 s5, s94, 43008
    s_waitcnt vmcnt(15)
    buffer_load_dwordx4 v[120:123], v8, s[48:51], s5 offen nt
    s_add_u32 s5, s94, 50176
    s_waitcnt vmcnt(15)
    buffer_load_dwordx4 v[124:127], v8, s[48:51], s5 offen nt
    v_mov_b32 v24, -1
    v_mov_b32 v25, -1
    v_mov_b32 v26, -1
    v_mov_b32 v27, -1
    s_lshl_b32 s80, s2, 12
    s_add_u32 s80, s80, 0x100000
    buffer_store_dwordx4 v[24:27], v5, s[56:59], s80 offen offset:0 sc1
    buffer_store_dwordx4 v[24:27], v5, s[56:59], s80 offen offset:1024 sc1
    buffer_store_dwordx4 v[24:27], v5, s[56:59], s80 offen offset:2048 sc1
    buffer_store_dwordx4 v[24:27], v5, s[56:59], s80 offen offset:3072 sc1
    s_mov_b32 exec_hi, 0
    buffer_store_dwordx4 v[24:27], v5, s[56:59], s95 offen sc1
    s_mov_b64 exec, 0xf
    s_lshl_b32 s80, s2, 6
    s_add_u32 s80, s80, 0x200000
    buffer_store_dwordx4 v[24:27], v5, s[56:59], s80 offen sc1
    s_mov_b64 exec, -1
    s_lshl_b32 s80, s2, 10
    s_add_u32 s80, s80, 0x400000
    buffer_store_dwordx4 v[24:27], v5, s[56:59], s80 offen sc1
    ds_write_b32 v12, v12 offset:4096
    ds_write_b32 v12, v12 offset:4100
    s_waitcnt lgkmcnt(0)
    s_barrier
    v_lshlrev_b32 v32, 16, v16
    v_and_b32 v33, 0xffff0000, v16
    v_lshlrev_b32 v34, 16, v17
    v_and_b32 v35, 0xffff0000, v17
    v_lshlrev_b32 v36, 16, v18
    v_and_b32 v37, 0xffff0000, v18
    v_lshlrev_b32 v38, 16, v19
    v_and_b32 v39, 0xffff0000, v19
    v_lshlrev_b32 v40, 16, v20
    v_and_b32 v41, 0xffff0000, v20
    v_lshlrev_b32 v42, 16, v21
    v_and_b32 v43, 0xffff0000, v21
    v_lshlrev_b32 v44, 16, v22
    v_and_b32 v45, 0xffff0000, v22
    v_lshlrev_b32 v46, 16, v23
    v_and_b32 v47, 0xffff0000, v23
    v_add_f32 v48, v32, v33
    v_add_f32 v48, v48, v34
    v_add_f32 v48, v48, v35
    v_add_f32 v48, v48, v36
    v_add_f32 v48, v48, v37
    v_add_f32 v48, v48, v38
    v_add_f32 v48, v48, v39
    v_add_f32 v48, v48, v40
    v_add_f32 v48, v48, v41
    v_add_f32 v48, v48, v42
    v_add_f32 v48, v48, v43
    v_add_f32 v48, v48, v44
    v_add_f32 v48, v48, v45
    v_add_f32 v48, v48, v46
    v_add_f32 v48, v48, v47
    s_nop 1
    v_add_f32_dpp v48, v48, v48 row_ror:1 row_mask:0xf bank_mask:0xf
    s_nop 1
    v_add_f32_dpp v48, v48, v48 row_ror:2 row_mask:0xf bank_mask:0xf
    s_nop 1
    v_add_f32_dpp v48, v48, v48 row_ror:4 row_mask:0xf bank_mask:0xf
    s_nop 1
    v_add_f32_dpp v48, v48, v48 row_ror:8 row_mask:0xf bank_mask:0xf
    v_mov_b32 v49, v48
    s_nop 1
    v_permlane16_swap_b32 v48, v49
    v_add_f32 v48, v48, v49
    v_mov_b32 v49, v48
    s_nop 1
    v_permlane32_swap_b32 v48, v49
    v_add_f32 v48, v48, v49
    v_mul_f32 v50, 0x3a800000, v48
    v_mov_b32 v48, 0
    v_sub_f32 v51, v32, v50
    v_fmac_f32 v48, v51, v51
    v_sub_f32 v51, v33, v50
    v_fmac_f32 v48, v51, v51
    v_sub_f32 v51, v34, v50
    v_fmac_f32 v48, v51, v51
    v_sub_f32 v51, v35, v50
    v_fmac_f32 v48, v51, v51
    v_sub_f32 v51, v36, v50
    v_fmac_f32 v48, v51, v51
    v_sub_f32 v51, v37, v50
    v_fmac_f32 v48, v51, v51
    v_sub_f32 v51, v38, v50
    v_fmac_f32 v48, v51, v51
    v_sub_f32 v51, v39, v50
    v_fmac_f32 v48, v51, v51
    v_sub_f32 v51, v40, v50
    v_fmac_f32 v48, v51, v51
    v_sub_f32 v51, v41, v50
    v_fmac_f32 v48, v51, v51
    v_sub_f32 v51, v42, v50
    v_fmac_f32 v48, v51, v51
    v_sub_f32 v51, v43, v50
    v_fmac_f32 v48, v51, v51
    v_sub_f32 v51, v44, v50
    v_fmac_f32 v48, v51, v51
    v_sub_f32 v51, v45, v50
    v_fmac_f32 v48, v51, v51
    v_sub_f32 v51, v46, v50
    v_fmac_f32 v48, v51, v51
    v_sub_f32 v51, v47, v50
    v_fmac_f32 v48, v51, v51
    s_nop 1
    v_add_f32_dpp v48, v48, v48 row_ror:1 row_mask:0xf bank_mask:0xf
    s_nop 1
    v_add_f32_dpp v48, v48, v48 row_ror:2 row_mask:0xf bank_mask:0xf
    s_nop 1
    v_add_f32_dpp v48, v48, v48 row_ror:4 row_mask:0xf bank_mask:0xf
    s_nop 1
    v_add_f32_dpp v48, v48, v48 row_ror:8 row_mask:0xf bank_mask:0xf
    v_mov_b32 v49, v48
    s_nop 1
    v_permlane16_swap_b32 v48, v49
    v_add_f32 v48, v48, v49
    v_mov_b32 v49, v48
    s_nop 1
    v_permlane32_swap_b32 v48, v49
    v_add_f32 v48, v48, v49
    v_mul_f32 v52, 0x3a800000, v48
    v_cvt_pk_bf16_f32 v53, v50, v50
    v_lshlrev_b32 v50, 16, v53
    v_cvt_pk_bf16_f32 v53, v52, v52
    v_lshlrev_b32 v52, 16, v53
    v_add_f32 v52, 0x3727c5ac, v52
    v_cvt_pk_bf16_f32 v53, v52, v52
    v_lshlrev_b32 v52, 16, v53
    v_sqrt_f32 v54, v52
    v_rcp_f32 v55, v54
    v_fma_f32 v56, -v54, v54, v52
    v_mul_f32 v55, 0.5, v55
    v_fmac_f32 v54, v56, v55
    v_cvt_pk_bf16_f32 v53, v54, v54
    v_lshlrev_b32 v54, 16, v53
    v_rcp_f32 v55, v54
    v_sub_f32 v32, v32, v50
    v_sub_f32 v33, v33, v50
    v_cvt_pk_bf16_f32 v53, v32, v33
    v_lshlrev_b32 v32, 16, v53
    v_and_b32 v33, 0xffff0000, v53
    v_mul_f32 v56, v32, v55
    v_fma_f32 v57, -v56, v54, v32
    v_fma_f32 v32, v57, v55, v56
    v_mul_f32 v56, v33, v55
    v_fma_f32 v57, -v56, v54, v33
    v_fma_f32 v33, v57, v55, v56
    v_cvt_pk_bf16_f32 v16, v32, v33
    v_sub_f32 v34, v34, v50
    v_sub_f32 v35, v35, v50
    v_cvt_pk_bf16_f32 v53, v34, v35
    v_lshlrev_b32 v34, 16, v53
    v_and_b32 v35, 0xffff0000, v53
    v_mul_f32 v56, v34, v55
    v_fma_f32 v57, -v56, v54, v34
    v_fma_f32 v34, v57, v55, v56
    v_mul_f32 v56, v35, v55
    v_fma_f32 v57, -v56, v54, v35
    v_fma_f32 v35, v57, v55, v56
    v_cvt_pk_bf16_f32 v17, v34, v35
    v_sub_f32 v36, v36, v50
    v_sub_f32 v37, v37, v50
    v_cvt_pk_bf16_f32 v53, v36, v37
    v_lshlrev_b32 v36, 16, v53
    v_and_b32 v37, 0xffff0000, v53
    v_mul_f32 v56, v36, v55
    v_fma_f32 v57, -v56, v54, v36
    v_fma_f32 v36, v57, v55, v56
    v_mul_f32 v56, v37, v55
    v_fma_f32 v57, -v56, v54, v37
    v_fma_f32 v37, v57, v55, v56
    v_cvt_pk_bf16_f32 v18, v36, v37
    v_sub_f32 v38, v38, v50
    v_sub_f32 v39, v39, v50
    v_cvt_pk_bf16_f32 v53, v38, v39
    v_lshlrev_b32 v38, 16, v53
    v_and_b32 v39, 0xffff0000, v53
    v_mul_f32 v56, v38, v55
    v_fma_f32 v57, -v56, v54, v38
    v_fma_f32 v38, v57, v55, v56
    v_mul_f32 v56, v39, v55
    v_fma_f32 v57, -v56, v54, v39
    v_fma_f32 v39, v57, v55, v56
    v_cvt_pk_bf16_f32 v19, v38, v39
    v_sub_f32 v40, v40, v50
    v_sub_f32 v41, v41, v50
    v_cvt_pk_bf16_f32 v53, v40, v41
    v_lshlrev_b32 v40, 16, v53
    v_and_b32 v41, 0xffff0000, v53
    v_mul_f32 v56, v40, v55
    v_fma_f32 v57, -v56, v54, v40
    v_fma_f32 v40, v57, v55, v56
    v_mul_f32 v56, v41, v55
    v_fma_f32 v57, -v56, v54, v41
    v_fma_f32 v41, v57, v55, v56
    v_cvt_pk_bf16_f32 v20, v40, v41
    v_sub_f32 v42, v42, v50
    v_sub_f32 v43, v43, v50
    v_cvt_pk_bf16_f32 v53, v42, v43
    v_lshlrev_b32 v42, 16, v53
    v_and_b32 v43, 0xffff0000, v53
    v_mul_f32 v56, v42, v55
    v_fma_f32 v57, -v56, v54, v42
    v_fma_f32 v42, v57, v55, v56
    v_mul_f32 v56, v43, v55
    v_fma_f32 v57, -v56, v54, v43
    v_fma_f32 v43, v57, v55, v56
    v_cvt_pk_bf16_f32 v21, v42, v43
    v_sub_f32 v44, v44, v50
    v_sub_f32 v45, v45, v50
    v_cvt_pk_bf16_f32 v53, v44, v45
    v_lshlrev_b32 v44, 16, v53
    v_and_b32 v45, 0xffff0000, v53
    v_mul_f32 v56, v44, v55
    v_fma_f32 v57, -v56, v54, v44
    v_fma_f32 v44, v57, v55, v56
    v_mul_f32 v56, v45, v55
    v_fma_f32 v57, -v56, v54, v45
    v_fma_f32 v45, v57, v55, v56
    v_cvt_pk_bf16_f32 v22, v44, v45
    v_sub_f32 v46, v46, v50
    v_sub_f32 v47, v47, v50
    v_cvt_pk_bf16_f32 v53, v46, v47
    v_lshlrev_b32 v46, 16, v53
    v_and_b32 v47, 0xffff0000, v53
    v_mul_f32 v56, v46, v55
    v_fma_f32 v57, -v56, v54, v46
    v_fma_f32 v46, v57, v55, v56
    v_mul_f32 v56, v47, v55
    v_fma_f32 v57, -v56, v54, v47
    v_fma_f32 v47, v57, v55, v56
    v_cvt_pk_bf16_f32 v23, v46, v47
    ds_write_b128 v6, v[16:19] offset:0
    ds_write_b128 v6, v[20:23] offset:16
    v_lshlrev_b32 v8, 4, v3
    s_lshl_b32 s80, s77, 8
    v_add_u32 v8, s80, v8
    s_waitcnt lgkmcnt(0)
    s_waitcnt vmcnt(0)
    ds_read_b128 v[16:19], v8 offset:0
    ds_read_b128 v[20:23], v8 offset:64
    ds_read_b128 v[24:27], v8 offset:128
    ds_read_b128 v[28:31], v8 offset:192
    v_mov_b32 v9, 1
    ds_write_b32 v12, v9 offset:4096
    s_waitcnt lgkmcnt(0)
    v_perm_b32 v64, v132, v128, s72
    v_perm_b32 v65, v140, v136, s72
    v_perm_b32 v66, v148, v144, s72
    v_perm_b32 v67, v156, v152, s72
    v_perm_b32 v68, v132, v128, s73
    v_perm_b32 v69, v140, v136, s73
    v_perm_b32 v70, v148, v144, s73
    v_perm_b32 v71, v156, v152, s73
    v_mfma_f32_16x16x32_bf16 v[32:35], v[16:19], v[64:67], 0
    v_perm_b32 v72, v133, v129, s72
    v_perm_b32 v73, v141, v137, s72
    v_perm_b32 v74, v149, v145, s72
    v_perm_b32 v75, v157, v153, s72
    v_mfma_f32_16x16x32_bf16 v[36:39], v[16:19], v[68:71], 0
    v_perm_b32 v76, v133, v129, s73
    v_perm_b32 v77, v141, v137, s73
    v_perm_b32 v78, v149, v145, s73
    v_perm_b32 v79, v157, v153, s73
    v_mfma_f32_16x16x32_bf16 v[40:43], v[16:19], v[72:75], 0
    v_perm_b32 v64, v134, v130, s72
    v_perm_b32 v65, v142, v138, s72
    v_perm_b32 v66, v150, v146, s72
    v_perm_b32 v67, v158, v154, s72
    v_mfma_f32_16x16x32_bf16 v[44:47], v[16:19], v[76:79], 0
    v_perm_b32 v68, v134, v130, s73
    v_perm_b32 v69, v142, v138, s73
    v_perm_b32 v70, v150, v146, s73
    v_perm_b32 v71, v158, v154, s73
    v_mfma_f32_16x16x32_bf16 v[48:51], v[16:19], v[64:67], 0
    v_perm_b32 v72, v135, v131, s72
    v_perm_b32 v73, v143, v139, s72
    v_perm_b32 v74, v151, v147, s72
    v_perm_b32 v75, v159, v155, s72
    v_mfma_f32_16x16x32_bf16 v[52:55], v[16:19], v[68:71], 0
    v_perm_b32 v76, v135, v131, s73
    v_perm_b32 v77, v143, v139, s73
    v_perm_b32 v78, v151, v147, s73
    v_perm_b32 v79, v159, v155, s73
    v_mfma_f32_16x16x32_bf16 v[56:59], v[16:19], v[72:75], 0
    s_nop 0
    v_mfma_f32_16x16x32_bf16 v[60:63], v[16:19], v[76:79], 0
    v_perm_b32 v64, v164, v160, s72
    v_perm_b32 v65, v172, v168, s72
    v_perm_b32 v66, v180, v176, s72
    v_perm_b32 v67, v188, v184, s72
    v_perm_b32 v68, v164, v160, s73
    v_perm_b32 v69, v172, v168, s73
    v_perm_b32 v70, v180, v176, s73
    v_perm_b32 v71, v188, v184, s73
    v_mfma_f32_16x16x32_bf16 v[32:35], v[20:23], v[64:67], v[32:35]
    v_perm_b32 v72, v165, v161, s72
    v_perm_b32 v73, v173, v169, s72
    v_perm_b32 v74, v181, v177, s72
    v_perm_b32 v75, v189, v185, s72
    v_mfma_f32_16x16x32_bf16 v[36:39], v[20:23], v[68:71], v[36:39]
    v_perm_b32 v76, v165, v161, s73
    v_perm_b32 v77, v173, v169, s73
    v_perm_b32 v78, v181, v177, s73
    v_perm_b32 v79, v189, v185, s73
    v_mfma_f32_16x16x32_bf16 v[40:43], v[20:23], v[72:75], v[40:43]
    v_perm_b32 v64, v166, v162, s72
    v_perm_b32 v65, v174, v170, s72
    v_perm_b32 v66, v182, v178, s72
    v_perm_b32 v67, v190, v186, s72
    v_mfma_f32_16x16x32_bf16 v[44:47], v[20:23], v[76:79], v[44:47]
    v_perm_b32 v68, v166, v162, s73
    v_perm_b32 v69, v174, v170, s73
    v_perm_b32 v70, v182, v178, s73
    v_perm_b32 v71, v190, v186, s73
    v_mfma_f32_16x16x32_bf16 v[48:51], v[20:23], v[64:67], v[48:51]
    v_perm_b32 v72, v167, v163, s72
    v_perm_b32 v73, v175, v171, s72
    v_perm_b32 v74, v183, v179, s72
    v_perm_b32 v75, v191, v187, s72
    v_mfma_f32_16x16x32_bf16 v[52:55], v[20:23], v[68:71], v[52:55]
    v_perm_b32 v76, v167, v163, s73
    v_perm_b32 v77, v175, v171, s73
    v_perm_b32 v78, v183, v179, s73
    v_perm_b32 v79, v191, v187, s73
    v_mfma_f32_16x16x32_bf16 v[56:59], v[20:23], v[72:75], v[56:59]
    s_nop 0
    v_mfma_f32_16x16x32_bf16 v[60:63], v[20:23], v[76:79], v[60:63]
    v_perm_b32 v64, v196, v192, s72
    v_perm_b32 v65, v204, v200, s72
    v_perm_b32 v66, v212, v208, s72
    v_perm_b32 v67, v220, v216, s72
    v_perm_b32 v68, v196, v192, s73
    v_perm_b32 v69, v204, v200, s73
    v_perm_b32 v70, v212, v208, s73
    v_perm_b32 v71, v220, v216, s73
    v_mfma_f32_16x16x32_bf16 v[32:35], v[24:27], v[64:67], v[32:35]
    v_perm_b32 v72, v197, v193, s72
    v_perm_b32 v73, v205, v201, s72
    v_perm_b32 v74, v213, v209, s72
    v_perm_b32 v75, v221, v217, s72
    v_mfma_f32_16x16x32_bf16 v[36:39], v[24:27], v[68:71], v[36:39]
    v_perm_b32 v76, v197, v193, s73
    v_perm_b32 v77, v205, v201, s73
    v_perm_b32 v78, v213, v209, s73
    v_perm_b32 v79, v221, v217, s73
    v_mfma_f32_16x16x32_bf16 v[40:43], v[24:27], v[72:75], v[40:43]
    v_perm_b32 v64, v198, v194, s72
    v_perm_b32 v65, v206, v202, s72
    v_perm_b32 v66, v214, v210, s72
    v_perm_b32 v67, v222, v218, s72
    v_mfma_f32_16x16x32_bf16 v[44:47], v[24:27], v[76:79], v[44:47]
    v_perm_b32 v68, v198, v194, s73
    v_perm_b32 v69, v206, v202, s73
    v_perm_b32 v70, v214, v210, s73
    v_perm_b32 v71, v222, v218, s73
    v_mfma_f32_16x16x32_bf16 v[48:51], v[24:27], v[64:67], v[48:51]
    v_perm_b32 v72, v199, v195, s72
    v_perm_b32 v73, v207, v203, s72
    v_perm_b32 v74, v215, v211, s72
    v_perm_b32 v75, v223, v219, s72
    v_mfma_f32_16x16x32_bf16 v[52:55], v[24:27], v[68:71], v[52:55]
    v_perm_b32 v76, v199, v195, s73
    v_perm_b32 v77, v207, v203, s73
    v_perm_b32 v78, v215, v211, s73
    v_perm_b32 v79, v223, v219, s73
    v_mfma_f32_16x16x32_bf16 v[56:59], v[24:27], v[72:75], v[56:59]
    s_nop 0
    v_mfma_f32_16x16x32_bf16 v[60:63], v[24:27], v[76:79], v[60:63]
    v_perm_b32 v64, v228, v224, s72
    v_perm_b32 v65, v236, v232, s72
    v_perm_b32 v66, v244, v240, s72
    v_perm_b32 v67, v252, v248, s72
    v_perm_b32 v68, v228, v224, s73
    v_perm_b32 v69, v236, v232, s73
    v_perm_b32 v70, v244, v240, s73
    v_perm_b32 v71, v252, v248, s73
    v_mfma_f32_16x16x32_bf16 v[32:35], v[28:31], v[64:67], v[32:35]
    v_perm_b32 v72, v229, v225, s72
    v_perm_b32 v73, v237, v233, s72
    v_perm_b32 v74, v245, v241, s72
    v_perm_b32 v75, v253, v249, s72
    v_mfma_f32_16x16x32_bf16 v[36:39], v[28:31], v[68:71], v[36:39]
    v_perm_b32 v76, v229, v225, s73
    v_perm_b32 v77, v237, v233, s73
    v_perm_b32 v78, v245, v241, s73
    v_perm_b32 v79, v253, v249, s73
    v_mfma_f32_16x16x32_bf16 v[40:43], v[28:31], v[72:75], v[40:43]
    v_perm_b32 v64, v230, v226, s72
    v_perm_b32 v65, v238, v234, s72
    v_perm_b32 v66, v246, v242, s72
    v_perm_b32 v67, v254, v250, s72
    v_mfma_f32_16x16x32_bf16 v[44:47], v[28:31], v[76:79], v[44:47]
    v_perm_b32 v68, v230, v226, s73
    v_perm_b32 v69, v238, v234, s73
    v_perm_b32 v70, v246, v242, s73
    v_perm_b32 v71, v254, v250, s73
    v_mfma_f32_16x16x32_bf16 v[48:51], v[28:31], v[64:67], v[48:51]
    v_perm_b32 v72, v231, v227, s72
    v_perm_b32 v73, v239, v235, s72
    v_perm_b32 v74, v247, v243, s72
    v_perm_b32 v75, v255, v251, s72
    v_mfma_f32_16x16x32_bf16 v[52:55], v[28:31], v[68:71], v[52:55]
    v_perm_b32 v76, v231, v227, s73
    v_perm_b32 v77, v239, v235, s73
    v_perm_b32 v78, v247, v243, s73
    v_perm_b32 v79, v255, v251, s73
    v_mfma_f32_16x16x32_bf16 v[56:59], v[28:31], v[72:75], v[56:59]
    s_nop 0
    v_mfma_f32_16x16x32_bf16 v[60:63], v[28:31], v[76:79], v[60:63]
    v_mov_b32 v16, v32
    v_mov_b32 v17, v36
    v_mov_b32 v18, v40
    v_mov_b32 v19, v44
    v_mov_b32 v20, v48
    v_mov_b32 v21, v52
    v_mov_b32 v22, v56
    s_nop 0
    v_mov_b32 v23, v60
    v_lshlrev_b32 v8, 5, v2
    s_lshl_b32 s80, s78, 15
    s_lshl_b32 s81, s77, 12
    s_add_u32 s80, s80, s81
    s_and_b32 s81, s76, 7
    s_lshl_b32 s81, s81, 9
    s_add_u32 s81, s80, s81
    s_mov_b64 exec, 0xffff
    buffer_store_dwordx4 v[16:19], v8, s[56:59], s81 offen sc1
    buffer_store_dwordx4 v[20:23], v8, s[56:59], s81 offen offset:16 sc1
    s_mov_b64 exec, -1
    s_nop 0
L_npoll_14:
    buffer_load_dwordx2 v[28:29], v12, s[68:71], 0 offen offset:8 sc1
    s_waitcnt vmcnt(0)
    v_readfirstlane_b32 s98, v28
    v_readfirstlane_b32 s99, v29
    s_nop 3
    s_cmp_lg_u32 s98, 0
    s_cbranch_scc1 L_nok_13
    s_add_u32 s7, s7, 1
    s_cmp_ge_u32 s7, 200000
    s_cbranch_scc1 L_nok_13
    s_sleep 8
    s_branch L_npoll_14
L_nok_13:
    s_lshl_b32 s85, s78, 12
    s_add_u32 s85, s85, 0x470000
    s_and_b32 s81, s2, 63
    s_lshl_b32 s81, s81, 3
    s_add_u32 s81, s81, s85
    s_mov_b64 exec, 1
    buffer_store_dwordx2 v[28:29], v12, s[56:59], s81 offen sc1
    s_mov_b64 exec, -1
    v_lshlrev_b32 v6, 4, v3
    s_and_b32 s80, s2, 3
    s_lshl_b32 s80, s80, 9
    s_lshl_b32 s81, s3, 6
    s_add_u32 s80, s80, s81
    v_add_u32 v6, s80, v6
    ds_read_b128 v[16:19], v6 offset:0
    s_waitcnt lgkmcnt(0)
    v_perm_b32 v64, v100, v96, s72
    v_perm_b32 v65, v108, v104, s72
    v_perm_b32 v66, v116, v112, s72
    v_perm_b32 v67, v124, v120, s72
    v_perm_b32 v68, v100, v96, s73
    v_perm_b32 v69, v108, v104, s73
    v_perm_b32 v70, v116, v112, s73
    v_perm_b32 v71, v124, v120, s73
    v_mfma_f32_16x16x32_bf16 v[32:35], v[16:19], v[64:67], 0
    v_perm_b32 v72, v101, v97, s72
    v_perm_b32 v73, v109, v105, s72
    v_perm_b32 v74, v117, v113, s72
    v_perm_b32 v75, v125, v121, s72
    v_mfma_f32_16x16x32_bf16 v[36:39], v[16:19], v[68:71], 0
    v_perm_b32 v76, v101, v97, s73
    v_perm_b32 v77, v109, v105, s73
    v_perm_b32 v78, v117, v113, s73
    v_perm_b32 v79, v125, v121, s73
    v_mfma_f32_16x16x32_bf16 v[40:43], v[16:19], v[72:75], 0
    v_perm_b32 v64, v102, v98, s72
    v_perm_b32 v65, v110, v106, s72
    v_perm_b32 v66, v118, v114, s72
    v_perm_b32 v67, v126, v122, s72
    v_mfma_f32_16x16x32_bf16 v[44:47], v[16:19], v[76:79], 0
    v_perm_b32 v68, v102, v98, s73
    v_perm_b32 v69, v110, v106, s73
    v_perm_b32 v70, v118, v114, s73
    v_perm_b32 v71, v126, v122, s73
    v_mfma_f32_16x16x32_bf16 v[48:51], v[16:19], v[64:67], 0
    v_perm_b32 v72, v103, v99, s72
    v_perm_b32 v73, v111, v107, s72
    v_perm_b32 v74, v119, v115, s72
    v_perm_b32 v75, v127, v123, s72
    v_mfma_f32_16x16x32_bf16 v[52:55], v[16:19], v[68:71], 0
    v_perm_b32 v76, v103, v99, s73
    v_perm_b32 v77, v111, v107, s73
    v_perm_b32 v78, v119, v115, s73
    v_perm_b32 v79, v127, v123, s73
    v_mfma_f32_16x16x32_bf16 v[56:59], v[16:19], v[72:75], 0
    s_nop 0
    v_mfma_f32_16x16x32_bf16 v[60:63], v[16:19], v[76:79], 0
    v_mov_b32 v20, v32
    v_mov_b32 v21, v36
    v_mov_b32 v22, v40
    v_mov_b32 v23, v44
    v_mov_b32 v24, v48
    v_mov_b32 v25, v52
    v_mov_b32 v26, v56
    s_nop 0
    v_mov_b32 v27, v60
    s_lshl_b32 s81, s3, 9
    v_lshlrev_b32 v6, 5, v2
    v_add_u32 v6, s81, v6
    s_mov_b64 exec, 0xffff
    ds_write_b128 v6, v[20:23] offset:50688
    ds_write_b128 v6, v[24:27] offset:50704
    s_mov_b64 exec, 1
    v_mov_b32 v7, 1
    s_waitcnt lgkmcnt(0)
    ds_add_u32 v12, v7 offset:4100
    s_mov_b64 exec, -1
    s_add_u32 s5, s4, 0x0
    buffer_load_dwordx4 v[128:131], v4, s[32:35], s5 offen offset:0 nt
    s_add_u32 s5, s4, 0x0
    buffer_load_dwordx4 v[132:135], v4, s[32:35], s5 offen offset:128 nt
    s_add_u32 s5, s4, 0x100000
    buffer_load_dwordx4 v[136:139], v4, s[32:35], s5 offen offset:0 nt
    s_add_u32 s5, s4, 0x100000
    buffer_load_dwordx4 v[140:143], v4, s[32:35], s5 offen offset:128 nt
    s_add_u32 s5, s4, 0x200000
    buffer_load_dwordx4 v[144:147], v4, s[32:35], s5 offen offset:0 nt
    s_add_u32 s5, s4, 0x200000
    buffer_load_dwordx4 v[148:151], v4, s[32:35], s5 offen offset:128 nt
    s_add_u32 s5, s4, 0x300000
    buffer_load_dwordx4 v[152:155], v4, s[32:35], s5 offen offset:0 nt
    s_add_u32 s5, s4, 0x300000
    s_waitcnt vmcnt(7)
    buffer_load_dwordx4 v[156:159], v4, s[32:35], s5 offen offset:128 nt
    s_add_u32 s5, s4, 0x400000
    s_waitcnt vmcnt(7)
    buffer_load_dwordx4 v[160:163], v4, s[32:35], s5 offen offset:0 nt
    s_add_u32 s5, s4, 0x400000
    s_waitcnt vmcnt(7)
    buffer_load_dwordx4 v[164:167], v4, s[32:35], s5 offen offset:128 nt
    s_add_u32 s5, s4, 0x500000
    s_waitcnt vmcnt(7)
    buffer_load_dwordx4 v[168:171], v4, s[32:35], s5 offen offset:0 nt
    s_add_u32 s5, s4, 0x500000
    s_waitcnt vmcnt(7)
    buffer_load_dwordx4 v[172:175], v4, s[32:35], s5 offen offset:128 nt
    s_add_u32 s5, s4, 0x600000
    s_waitcnt vmcnt(7)
    buffer_load_dwordx4 v[176:179], v4, s[32:35], s5 offen offset:0 nt
    s_add_u32 s5, s4, 0x600000
    s_waitcnt vmcnt(7)
    buffer_load_dwordx4 v[180:183], v4, s[32:35], s5 offen offset:128 nt
    s_add_u32 s5, s4, 0x700000
    s_waitcnt vmcnt(7)
    buffer_load_dwordx4 v[184:187], v4, s[32:35], s5 offen offset:0 nt
    s_add_u32 s5, s4, 0x700000
    s_waitcnt vmcnt(7)
    buffer_load_dwordx4 v[188:191], v4, s[32:35], s5 offen offset:128 nt
    v_lshlrev_b32 v9, 3, v0
    s_nop 1
L_fpoll_15:
    buffer_load_dwordx2 v[16:17], v9, s[56:59], s85 offen sc1
    s_waitcnt vmcnt(0)
    v_xor_b32 v16, s98, v16
    v_xor_b32 v17, s99, v17
    v_or_b32 v16, v16, v17
    v_cmp_ne_u32 vcc, 0, v16
    s_nop 1
    s_cbranch_vccz L_fpolld_16
    s_add_u32 s7, s7, 1
    s_cmp_ge_u32 s7, 200000
    s_cbranch_scc1 L_fpolld_16
    s_sleep 4
    s_branch L_fpoll_15
L_fpolld_16:
    s_lshl_b32 s80, s78, 15
    s_add_u32 s5, s80, 0x0
    buffer_load_dwordx4 v[64:67], v5, s[56:59], s5 offen offset:0 sc1
    buffer_load_dwordx4 v[68:71], v5, s[56:59], s5 offen offset:1024 sc1
    buffer_load_dwordx4 v[72:75], v5, s[56:59], s5 offen offset:2048 sc1
    buffer_load_dwordx4 v[76:79], v5, s[56:59], s5 offen offset:3072 sc1
    s_add_u32 s5, s80, 0x1000
    buffer_load_dwordx4 v[80:83], v5, s[56:59], s5 offen offset:0 sc1
    buffer_load_dwordx4 v[84:87], v5, s[56:59], s5 offen offset:1024 sc1
    buffer_load_dwordx4 v[88:91], v5, s[56:59], s5 offen offset:2048 sc1
    buffer_load_dwordx4 v[92:95], v5, s[56:59], s5 offen offset:3072 sc1
    s_add_u32 s5, s80, 0x2000
    buffer_load_dwordx4 v[96:99], v5, s[56:59], s5 offen offset:0 sc1
    buffer_load_dwordx4 v[100:103], v5, s[56:59], s5 offen offset:1024 sc1
    buffer_load_dwordx4 v[104:107], v5, s[56:59], s5 offen offset:2048 sc1
    buffer_load_dwordx4 v[108:111], v5, s[56:59], s5 offen offset:3072 sc1
    s_add_u32 s5, s80, 0x3000
    buffer_load_dwordx4 v[112:115], v5, s[56:59], s5 offen offset:0 sc1
    buffer_load_dwordx4 v[116:119], v5, s[56:59], s5 offen offset:1024 sc1
    buffer_load_dwordx4 v[120:123], v5, s[56:59], s5 offen offset:2048 sc1
    buffer_load_dwordx4 v[124:127], v5, s[56:59], s5 offen offset:3072 sc1
    s_waitcnt vmcnt(12)
    v_mov_b32 v32, v64
    v_mov_b32 v33, v65
    v_mov_b32 v34, v66
    v_mov_b32 v35, v67
    v_mov_b32 v36, v68
    v_mov_b32 v37, v69
    v_mov_b32 v38, v70
    v_mov_b32 v39, v71
    v_mov_b32 v40, v72
    v_mov_b32 v41, v73
    v_mov_b32 v42, v74
    v_mov_b32 v43, v75
    v_mov_b32 v44, v76
    v_mov_b32 v45, v77
    v_mov_b32 v46, v78
    v_mov_b32 v47, v79
    s_waitcnt vmcnt(8)
    v_add_f32 v32, v32, v80
    v_add_f32 v33, v33, v81
    v_add_f32 v34, v34, v82
    v_add_f32 v35, v35, v83
    v_add_f32 v36, v36, v84
    v_add_f32 v37, v37, v85
    v_add_f32 v38, v38, v86
    v_add_f32 v39, v39, v87
    v_add_f32 v40, v40, v88
    v_add_f32 v41, v41, v89
    v_add_f32 v42, v42, v90
    v_add_f32 v43, v43, v91
    v_add_f32 v44, v44, v92
    v_add_f32 v45, v45, v93
    v_add_f32 v46, v46, v94
    v_add_f32 v47, v47, v95
    s_waitcnt vmcnt(4)
    v_add_f32 v32, v32, v96
    v_add_f32 v33, v33, v97
    v_add_f32 v34, v34, v98
    v_add_f32 v35, v35, v99
    v_add_f32 v36, v36, v100
    v_add_f32 v37, v37, v101
    v_add_f32 v38, v38, v102
    v_add_f32 v39, v39, v103
    v_add_f32 v40, v40, v104
    v_add_f32 v41, v41, v105
    v_add_f32 v42, v42, v106
    v_add_f32 v43, v43, v107
    v_add_f32 v44, v44, v108
    v_add_f32 v45, v45, v109
    v_add_f32 v46, v46, v110
    v_add_f32 v47, v47, v111
    s_waitcnt vmcnt(0)
    v_add_f32 v32, v32, v112
    v_add_f32 v33, v33, v113
    v_add_f32 v34, v34, v114
    v_add_f32 v35, v35, v115
    v_add_f32 v36, v36, v116
    v_add_f32 v37, v37, v117
    v_add_f32 v38, v38, v118
    v_add_f32 v39, v39, v119
    v_add_f32 v40, v40, v120
    v_add_f32 v41, v41, v121
    v_add_f32 v42, v42, v122
    v_add_f32 v43, v43, v123
    v_add_f32 v44, v44, v124
    v_add_f32 v45, v45, v125
    v_add_f32 v46, v46, v126
    v_add_f32 v47, v47, v127
    s_add_u32 s5, s80, 0x4000
    buffer_load_dwordx4 v[64:67], v5, s[56:59], s5 offen offset:0 sc1
    buffer_load_dwordx4 v[68:71], v5, s[56:59], s5 offen offset:1024 sc1
    buffer_load_dwordx4 v[72:75], v5, s[56:59], s5 offen offset:2048 sc1
    buffer_load_dwordx4 v[76:79], v5, s[56:59], s5 offen offset:3072 sc1
    s_add_u32 s5, s80, 0x5000
    buffer_load_dwordx4 v[80:83], v5, s[56:59], s5 offen offset:0 sc1
    buffer_load_dwordx4 v[84:87], v5, s[56:59], s5 offen offset:1024 sc1
    buffer_load_dwordx4 v[88:91], v5, s[56:59], s5 offen offset:2048 sc1
    buffer_load_dwordx4 v[92:95], v5, s[56:59], s5 offen offset:3072 sc1
    s_add_u32 s5, s80, 0x6000
    buffer_load_dwordx4 v[96:99], v5, s[56:59], s5 offen offset:0 sc1
    buffer_load_dwordx4 v[100:103], v5, s[56:59], s5 offen offset:1024 sc1
    buffer_load_dwordx4 v[104:107], v5, s[56:59], s5 offen offset:2048 sc1
    buffer_load_dwordx4 v[108:111], v5, s[56:59], s5 offen offset:3072 sc1
    s_add_u32 s5, s80, 0x7000
    buffer_load_dwordx4 v[112:115], v5, s[56:59], s5 offen offset:0 sc1
    buffer_load_dwordx4 v[116:119], v5, s[56:59], s5 offen offset:1024 sc1
    buffer_load_dwordx4 v[120:123], v5, s[56:59], s5 offen offset:2048 sc1
    buffer_load_dwordx4 v[124:127], v5, s[56:59], s5 offen offset:3072 sc1
    s_waitcnt vmcnt(12)
    v_add_f32 v32, v32, v64
    v_add_f32 v33, v33, v65
    v_add_f32 v34, v34, v66
    v_add_f32 v35, v35, v67
    v_add_f32 v36, v36, v68
    v_add_f32 v37, v37, v69
    v_add_f32 v38, v38, v70
    v_add_f32 v39, v39, v71
    v_add_f32 v40, v40, v72
    v_add_f32 v41, v41, v73
    v_add_f32 v42, v42, v74
    v_add_f32 v43, v43, v75
    v_add_f32 v44, v44, v76
    v_add_f32 v45, v45, v77
    v_add_f32 v46, v46, v78
    v_add_f32 v47, v47, v79
    s_waitcnt vmcnt(8)
    v_add_f32 v32, v32, v80
    v_add_f32 v33, v33, v81
    v_add_f32 v34, v34, v82
    v_add_f32 v35, v35, v83
    v_add_f32 v36, v36, v84
    v_add_f32 v37, v37, v85
    v_add_f32 v38, v38, v86
    v_add_f32 v39, v39, v87
    v_add_f32 v40, v40, v88
    v_add_f32 v41, v41, v89
    v_add_f32 v42, v42, v90
    v_add_f32 v43, v43, v91
    v_add_f32 v44, v44, v92
    v_add_f32 v45, v45, v93
    v_add_f32 v46, v46, v94
    v_add_f32 v47, v47, v95
    s_waitcnt vmcnt(4)
    v_add_f32 v32, v32, v96
    v_add_f32 v33, v33, v97
    v_add_f32 v34, v34, v98
    v_add_f32 v35, v35, v99
    v_add_f32 v36, v36, v100
    v_add_f32 v37, v37, v101
    v_add_f32 v38, v38, v102
    v_add_f32 v39, v39, v103
    v_add_f32 v40, v40, v104
    v_add_f32 v41, v41, v105
    v_add_f32 v42, v42, v106
    v_add_f32 v43, v43, v107
    v_add_f32 v44, v44, v108
    v_add_f32 v45, v45, v109
    v_add_f32 v46, v46, v110
    v_add_f32 v47, v47, v111
    s_waitcnt vmcnt(0)
    v_add_f32 v32, v32, v112
    v_add_f32 v33, v33, v113
    v_add_f32 v34, v34, v114
    v_add_f32 v35, v35, v115
    v_add_f32 v36, v36, v116
    v_add_f32 v37, v37, v117
    v_add_f32 v38, v38, v118
    v_add_f32 v39, v39, v119
    v_add_f32 v40, v40, v120
    v_add_f32 v41, v41, v121
    v_add_f32 v42, v42, v122
    v_add_f32 v43, v43, v123
    v_add_f32 v44, v44, v124
    v_add_f32 v45, v45, v125
    v_add_f32 v46, v46, v126
    v_add_f32 v47, v47, v127
    v_lshlrev_b32 v8, 3, v0
    v_cvt_pk_bf16_f32 v16, v32, v33
    v_cvt_pk_bf16_f32 v17, v34, v35
    ds_write_b64 v8, v[16:17] offset:2048
    v_cvt_pk_bf16_f32 v18, v36, v37
    v_cvt_pk_bf16_f32 v19, v38, v39
    ds_write_b64 v8, v[18:19] offset:2560
    v_cvt_pk_bf16_f32 v20, v40, v41
    v_cvt_pk_bf16_f32 v21, v42, v43
    ds_write_b64 v8, v[20:21] offset:3072
    v_cvt_pk_bf16_f32 v22, v44, v45
    v_cvt_pk_bf16_f32 v23, v46, v47
    ds_write_b64 v8, v[22:23] offset:3584
    v_mov_b32 v10, 2
    s_waitcnt lgkmcnt(0)
    ds_write_b32 v12, v10 offset:4096
    s_mov_b32 s90, 0x470000
    s_mov_b32 s91, 0x471000
    s_mov_b32 s92, 0x472000
    s_mov_b32 s93, 0x473000
L_fpoll_17:
    buffer_load_dwordx2 v[16:17], v9, s[56:59], s90 offen sc1
    buffer_load_dwordx2 v[18:19], v9, s[56:59], s91 offen sc1
    buffer_load_dwordx2 v[20:21], v9, s[56:59], s92 offen sc1
    buffer_load_dwordx2 v[22:23], v9, s[56:59], s93 offen sc1
    s_waitcnt vmcnt(0)
    v_xor_b32 v16, s98, v16
    v_xor_b32 v17, s99, v17
    v_xor_b32 v18, s98, v18
    v_xor_b32 v19, s99, v19
    v_xor_b32 v20, s98, v20
    v_xor_b32 v21, s99, v21
    v_xor_b32 v22, s98, v22
    v_xor_b32 v23, s99, v23
    v_or_b32 v16, v16, v17
    v_or_b32 v16, v16, v18
    v_or_b32 v16, v16, v19
    v_or_b32 v16, v16, v20
    v_or_b32 v16, v16, v21
    v_or_b32 v16, v16, v22
    v_or_b32 v16, v16, v23
    v_cmp_ne_u32 vcc, 0, v16
    s_nop 1
    s_cbranch_vccz L_fpolld_18
    s_add_u32 s7, s7, 1
    s_cmp_ge_u32 s7, 200000
    s_cbranch_scc1 L_fpolld_18
    s_sleep 4
    s_branch L_fpoll_17
L_fpolld_18:
    v_mov_b32 v10, 3
    ds_write_b32 v12, v10 offset:4096
    s_nop 0
L_fl_19:
    ds_read_b32 v6, v12 offset:4100
    s_waitcnt lgkmcnt(0)
    v_readfirstlane_b32 s80, v6
    s_nop 3
    s_cmp_ge_u32 s80, 8
    s_cbranch_scc1 L_fld_20
    s_add_u32 s7, s7, 1
    s_cmp_ge_u32 s7, 200000
    s_cbranch_scc1 L_fld_20
    s_sleep 1
    s_branch L_fl_19
L_fld_20:
    ds_read_b128 v[64:67], v5 offset:50688
    ds_read_b128 v[68:71], v5 offset:51200
    ds_read_b128 v[72:75], v5 offset:51712
    ds_read_b128 v[76:79], v5 offset:52224
    ds_read_b128 v[80:83], v5 offset:52736
    ds_read_b128 v[84:87], v5 offset:53248
    ds_read_b128 v[88:91], v5 offset:53760
    ds_read_b128 v[92:95], v5 offset:54272
    s_waitcnt lgkmcnt(0)
    v_add_f32 v64, v64, v68
    v_add_f32 v65, v65, v69
    v_add_f32 v66, v66, v70
    v_add_f32 v67, v67, v71
    v_add_f32 v64, v64, v72
    v_add_f32 v65, v65, v73
    v_add_f32 v66, v66, v74
    v_add_f32 v67, v67, v75
    v_add_f32 v64, v64, v76
    v_add_f32 v65, v65, v77
    v_add_f32 v66, v66, v78
    v_add_f32 v67, v67, v79
    v_add_f32 v64, v64, v80
    v_add_f32 v65, v65, v81
    v_add_f32 v66, v66, v82
    v_add_f32 v67, v67, v83
    v_add_f32 v64, v64, v84
    v_add_f32 v65, v65, v85
    v_add_f32 v66, v66, v86
    v_add_f32 v67, v67, v87
    v_add_f32 v64, v64, v88
    v_add_f32 v65, v65, v89
    v_add_f32 v66, v66, v90
    v_add_f32 v67, v67, v91
    v_add_f32 v64, v64, v92
    v_add_f32 v65, v65, v93
    v_add_f32 v66, v66, v94
    v_add_f32 v67, v67, v95
    s_mov_b32 exec_hi, 0
    buffer_store_dwordx4 v[64:67], v5, s[56:59], s95 offen sc1
    s_mov_b64 exec, -1
    s_waitcnt vmcnt(0)
    s_add_u32 s5, s4, 0x800000
    buffer_load_dwordx4 v[192:195], v4, s[32:35], s5 offen offset:0 nt
    s_add_u32 s5, s4, 0x800000
    buffer_load_dwordx4 v[196:199], v4, s[32:35], s5 offen offset:128 nt
    s_add_u32 s5, s4, 0x900000
    buffer_load_dwordx4 v[200:203], v4, s[32:35], s5 offen offset:0 nt
    s_add_u32 s5, s4, 0x900000
    buffer_load_dwordx4 v[204:207], v4, s[32:35], s5 offen offset:128 nt
    s_add_u32 s5, s4, 0xa00000
    buffer_load_dwordx4 v[208:211], v4, s[32:35], s5 offen offset:0 nt
    s_add_u32 s5, s4, 0xa00000
    buffer_load_dwordx4 v[212:215], v4, s[32:35], s5 offen offset:128 nt
    s_add_u32 s5, s4, 0xb00000
    buffer_load_dwordx4 v[216:219], v4, s[32:35], s5 offen offset:0 nt
    s_add_u32 s5, s4, 0xb00000
    buffer_load_dwordx4 v[220:223], v4, s[32:35], s5 offen offset:128 nt
    s_add_u32 s5, s4, 0xc00000
    s_waitcnt vmcnt(7)
    buffer_load_dwordx4 v[224:227], v4, s[32:35], s5 offen offset:0 nt
    s_add_u32 s5, s4, 0xc00000
    s_waitcnt vmcnt(7)
    buffer_load_dwordx4 v[228:231], v4, s[32:35], s5 offen offset:128 nt
    s_add_u32 s5, s4, 0xd00000
    s_waitcnt vmcnt(7)
    buffer_load_dwordx4 v[232:235], v4, s[32:35], s5 offen offset:0 nt
    s_add_u32 s5, s4, 0xd00000
    s_waitcnt vmcnt(7)
    buffer_load_dwordx4 v[236:239], v4, s[32:35], s5 offen offset:128 nt
    s_add_u32 s5, s4, 0xe00000
    s_waitcnt vmcnt(7)
    buffer_load_dwordx4 v[240:243], v4, s[32:35], s5 offen offset:0 nt
    s_add_u32 s5, s4, 0xe00000
    s_waitcnt vmcnt(7)
    buffer_load_dwordx4 v[244:247], v4, s[32:35], s5 offen offset:128 nt
    s_add_u32 s5, s4, 0xf00000
    s_waitcnt vmcnt(7)
    buffer_load_dwordx4 v[248:251], v4, s[32:35], s5 offen offset:0 nt
    s_add_u32 s5, s4, 0xf00000
    s_waitcnt vmcnt(7)
    buffer_load_dwordx4 v[252:255], v4, s[32:35], s5 offen offset:128 nt
    s_add_u32 s6, s4, 0x0
    s_waitcnt vmcnt(7)
    buffer_load_dwordx4 v[64:67], v5, s[36:39], s6 offen nt
    s_add_u32 s6, s4, 0x80000
    s_waitcnt vmcnt(7)
    buffer_load_dwordx4 v[68:71], v5, s[36:39], s6 offen nt
    s_add_u32 s6, s4, 0x100000
    s_waitcnt vmcnt(7)
    buffer_load_dwordx4 v[72:75], v5, s[36:39], s6 offen nt
    s_add_u32 s6, s4, 0x180000
    s_waitcnt vmcnt(7)
    buffer_load_dwordx4 v[76:79], v5, s[36:39], s6 offen nt
    s_add_u32 s6, s4, 0x200000
    s_waitcnt vmcnt(7)
    buffer_load_dwordx4 v[80:83], v5, s[36:39], s6 offen nt
    s_add_u32 s6, s4, 0x280000
    s_waitcnt vmcnt(7)
    buffer_load_dwordx4 v[84:87], v5, s[36:39], s6 offen nt
    s_add_u32 s6, s4, 0x300000
    s_waitcnt vmcnt(7)
    buffer_load_dwordx4 v[88:91], v5, s[36:39], s6 offen nt
    s_add_u32 s6, s4, 0x380000
    s_waitcnt vmcnt(7)
    buffer_load_dwordx4 v[92:95], v5, s[36:39], s6 offen nt
    v_and_b32 v6, 7, v2
    v_lshlrev_b32 v6, 8, v6
    v_lshl_add_u32 v6, v3, 4, v6
    v_lshrrev_b32 v7, 3, v2
    v_lshl_add_u32 v6, v7, 6, v6
    ds_read_b128 v[16:19], v6 offset:2048
    ds_read_b128 v[20:23], v6 offset:2176
    s_waitcnt lgkmcnt(0)
    v_mfma_f32_16x16x32_bf16 v[24:27], v[128:131], v[16:19], 0
    v_mfma_f32_16x16x32_bf16 v[24:27], v[132:135], v[20:23], v[24:27]
    v_mfma_f32_16x16x32_bf16 v[128:131], v[136:139], v[16:19], 0
    v_mfma_f32_16x16x32_bf16 v[128:131], v[140:143], v[20:23], v[128:131]
    v_mfma_f32_16x16x32_bf16 v[136:139], v[144:147], v[16:19], 0
    v_mfma_f32_16x16x32_bf16 v[136:139], v[148:151], v[20:23], v[136:139]
    v_mfma_f32_16x16x32_bf16 v[144:147], v[152:155], v[16:19], 0
    v_mfma_f32_16x16x32_bf16 v[144:147], v[156:159], v[20:23], v[144:147]
    s_nop 1
    v_add_f32_dpp v32, v25, v24 row_ror:8 row_mask:0xf bank_mask:0xf
    v_add_f32_dpp v33, v27, v26 row_ror:8 row_mask:0xf bank_mask:0xf
    v_mfma_f32_16x16x32_bf16 v[152:155], v[160:163], v[16:19], 0
    v_mfma_f32_16x16x32_bf16 v[152:155], v[164:167], v[20:23], v[152:155]
    v_add_f32_dpp v34, v129, v128 row_ror:8 row_mask:0xf bank_mask:0xf
    v_add_f32_dpp v35, v131, v130 row_ror:8 row_mask:0xf bank_mask:0xf
    v_mfma_f32_16x16x32_bf16 v[160:163], v[168:171], v[16:19], 0
    v_mfma_f32_16x16x32_bf16 v[160:163], v[172:175], v[20:23], v[160:163]
    v_add_f32_dpp v36, v137, v136 row_ror:8 row_mask:0xf bank_mask:0xf
    v_add_f32_dpp v37, v139, v138 row_ror:8 row_mask:0xf bank_mask:0xf
    v_mfma_f32_16x16x32_bf16 v[168:171], v[176:179], v[16:19], 0
    v_mfma_f32_16x16x32_bf16 v[168:171], v[180:183], v[20:23], v[168:171]
    v_add_f32_dpp v38, v145, v144 row_ror:8 row_mask:0xf bank_mask:0xf
    v_add_f32_dpp v39, v147, v146 row_ror:8 row_mask:0xf bank_mask:0xf
    v_mfma_f32_16x16x32_bf16 v[176:179], v[184:187], v[16:19], 0
    v_mfma_f32_16x16x32_bf16 v[176:179], v[188:191], v[20:23], v[176:179]
    v_add_f32_dpp v40, v153, v152 row_ror:8 row_mask:0xf bank_mask:0xf
    v_add_f32_dpp v41, v155, v154 row_ror:8 row_mask:0xf bank_mask:0xf
    v_mfma_f32_16x16x32_bf16 v[184:187], v[192:195], v[16:19], 0
    v_mfma_f32_16x16x32_bf16 v[184:187], v[196:199], v[20:23], v[184:187]
    v_add_f32_dpp v42, v161, v160 row_ror:8 row_mask:0xf bank_mask:0xf
    v_add_f32_dpp v43, v163, v162 row_ror:8 row_mask:0xf bank_mask:0xf
    v_mfma_f32_16x16x32_bf16 v[192:195], v[200:203], v[16:19], 0
    v_mfma_f32_16x16x32_bf16 v[192:195], v[204:207], v[20:23], v[192:195]
    v_add_f32_dpp v44, v169, v168 row_ror:8 row_mask:0xf bank_mask:0xf
    v_add_f32_dpp v45, v171, v170 row_ror:8 row_mask:0xf bank_mask:0xf
    v_mfma_f32_16x16x32_bf16 v[200:203], v[208:211], v[16:19], 0
    v_mfma_f32_16x16x32_bf16 v[200:203], v[212:215], v[20:23], v[200:203]
    v_add_f32_dpp v46, v177, v176 row_ror:8 row_mask:0xf bank_mask:0xf
    v_add_f32_dpp v47, v179, v178 row_ror:8 row_mask:0xf bank_mask:0xf
    v_mfma_f32_16x16x32_bf16 v[208:211], v[216:219], v[16:19], 0
    v_mfma_f32_16x16x32_bf16 v[208:211], v[220:223], v[20:23], v[208:211]
    v_add_f32_dpp v48, v185, v184 row_ror:8 row_mask:0xf bank_mask:0xf
    v_add_f32_dpp v49, v187, v186 row_ror:8 row_mask:0xf bank_mask:0xf
    v_mfma_f32_16x16x32_bf16 v[216:219], v[224:227], v[16:19], 0
    v_mfma_f32_16x16x32_bf16 v[216:219], v[228:231], v[20:23], v[216:219]
    v_add_f32_dpp v50, v193, v192 row_ror:8 row_mask:0xf bank_mask:0xf
    v_add_f32_dpp v51, v195, v194 row_ror:8 row_mask:0xf bank_mask:0xf
    v_mfma_f32_16x16x32_bf16 v[224:227], v[232:235], v[16:19], 0
    v_mfma_f32_16x16x32_bf16 v[224:227], v[236:239], v[20:23], v[224:227]
    v_add_f32_dpp v52, v201, v200 row_ror:8 row_mask:0xf bank_mask:0xf
    v_add_f32_dpp v53, v203, v202 row_ror:8 row_mask:0xf bank_mask:0xf
    v_mfma_f32_16x16x32_bf16 v[232:235], v[240:243], v[16:19], 0
    v_mfma_f32_16x16x32_bf16 v[232:235], v[244:247], v[20:23], v[232:235]
    v_add_f32_dpp v54, v209, v208 row_ror:8 row_mask:0xf bank_mask:0xf
    v_add_f32_dpp v55, v211, v210 row_ror:8 row_mask:0xf bank_mask:0xf
    v_mfma_f32_16x16x32_bf16 v[240:243], v[248:251], v[16:19], 0
    v_mfma_f32_16x16x32_bf16 v[240:243], v[252:255], v[20:23], v[240:243]
    v_add_f32_dpp v56, v217, v216 row_ror:8 row_mask:0xf bank_mask:0xf
    v_add_f32_dpp v57, v219, v218 row_ror:8 row_mask:0xf bank_mask:0xf
    v_add_f32_dpp v58, v225, v224 row_ror:8 row_mask:0xf bank_mask:0xf
    v_add_f32_dpp v59, v227, v226 row_ror:8 row_mask:0xf bank_mask:0xf
    v_add_f32_dpp v60, v233, v232 row_ror:8 row_mask:0xf bank_mask:0xf
    v_add_f32_dpp v61, v235, v234 row_ror:8 row_mask:0xf bank_mask:0xf
    s_nop 1
    v_add_f32_dpp v62, v241, v240 row_ror:8 row_mask:0xf bank_mask:0xf
    v_add_f32_dpp v63, v243, v242 row_ror:8 row_mask:0xf bank_mask:0xf
    v_cvt_pk_bf16_f32 v6, v32, v33
    v_lshlrev_b32 v32, 16, v6
    v_and_b32 v33, 0xffff0000, v6
    v_mul_f32 v32, s74, v32
    v_mul_f32 v33, s74, v33
    v_cvt_pk_bf16_f32 v7, v32, v33
    v_lshlrev_b32 v32, 16, v7
    v_and_b32 v33, 0xffff0000, v7
    v_max_f32 v14, v32, v33
    v_cvt_pk_bf16_f32 v6, v34, v35
    v_lshlrev_b32 v34, 16, v6
    v_and_b32 v35, 0xffff0000, v6
    v_mul_f32 v34, s74, v34
    v_mul_f32 v35, s74, v35
    v_cvt_pk_bf16_f32 v7, v34, v35
    v_lshlrev_b32 v34, 16, v7
    v_and_b32 v35, 0xffff0000, v7
    v_max3_f32 v14, v14, v34, v35
    v_cvt_pk_bf16_f32 v6, v36, v37
    v_lshlrev_b32 v36, 16, v6
    v_and_b32 v37, 0xffff0000, v6
    v_mul_f32 v36, s74, v36
    v_mul_f32 v37, s74, v37
    v_cvt_pk_bf16_f32 v7, v36, v37
    v_lshlrev_b32 v36, 16, v7
    v_and_b32 v37, 0xffff0000, v7
    v_max3_f32 v14, v14, v36, v37
    v_cvt_pk_bf16_f32 v6, v38, v39
    v_lshlrev_b32 v38, 16, v6
    v_and_b32 v39, 0xffff0000, v6
    v_mul_f32 v38, s74, v38
    v_mul_f32 v39, s74, v39
    v_cvt_pk_bf16_f32 v7, v38, v39
    v_lshlrev_b32 v38, 16, v7
    v_and_b32 v39, 0xffff0000, v7
    v_max3_f32 v14, v14, v38, v39
    s_add_u32 s6, s4, 0x400000
    s_waitcnt vmcnt(7)
    buffer_load_dwordx4 v[96:99], v5, s[36:39], s6 offen nt
    v_cvt_pk_bf16_f32 v6, v40, v41
    v_lshlrev_b32 v40, 16, v6
    v_and_b32 v41, 0xffff0000, v6
    v_mul_f32 v40, s74, v40
    v_mul_f32 v41, s74, v41
    v_cvt_pk_bf16_f32 v7, v40, v41
    v_lshlrev_b32 v40, 16, v7
    v_and_b32 v41, 0xffff0000, v7
    v_max3_f32 v14, v14, v40, v41
    v_cvt_pk_bf16_f32 v6, v42, v43
    v_lshlrev_b32 v42, 16, v6
    v_and_b32 v43, 0xffff0000, v6
    v_mul_f32 v42, s74, v42
    v_mul_f32 v43, s74, v43
    v_cvt_pk_bf16_f32 v7, v42, v43
    v_lshlrev_b32 v42, 16, v7
    v_and_b32 v43, 0xffff0000, v7
    v_max3_f32 v14, v14, v42, v43
    v_cvt_pk_bf16_f32 v6, v44, v45
    v_lshlrev_b32 v44, 16, v6
    v_and_b32 v45, 0xffff0000, v6
    v_mul_f32 v44, s74, v44
    v_mul_f32 v45, s74, v45
    v_cvt_pk_bf16_f32 v7, v44, v45
    v_lshlrev_b32 v44, 16, v7
    v_and_b32 v45, 0xffff0000, v7
    v_max3_f32 v14, v14, v44, v45
    v_cvt_pk_bf16_f32 v6, v46, v47
    v_lshlrev_b32 v46, 16, v6
    v_and_b32 v47, 0xffff0000, v6
    v_mul_f32 v46, s74, v46
    v_mul_f32 v47, s74, v47
    v_cvt_pk_bf16_f32 v7, v46, v47
    v_lshlrev_b32 v46, 16, v7
    v_and_b32 v47, 0xffff0000, v7
    v_max3_f32 v14, v14, v46, v47
    s_add_u32 s6, s4, 0x480000
    s_waitcnt vmcnt(7)
    buffer_load_dwordx4 v[100:103], v5, s[36:39], s6 offen nt
    v_cvt_pk_bf16_f32 v6, v48, v49
    v_lshlrev_b32 v48, 16, v6
    v_and_b32 v49, 0xffff0000, v6
    v_mul_f32 v48, s74, v48
    v_mul_f32 v49, s74, v49
    v_cvt_pk_bf16_f32 v7, v48, v49
    v_lshlrev_b32 v48, 16, v7
    v_and_b32 v49, 0xffff0000, v7
    v_max3_f32 v14, v14, v48, v49
    v_cvt_pk_bf16_f32 v6, v50, v51
    v_lshlrev_b32 v50, 16, v6
    v_and_b32 v51, 0xffff0000, v6
    v_mul_f32 v50, s74, v50
    v_mul_f32 v51, s74, v51
    v_cvt_pk_bf16_f32 v7, v50, v51
    v_lshlrev_b32 v50, 16, v7
    v_and_b32 v51, 0xffff0000, v7
    v_max3_f32 v14, v14, v50, v51
    v_cvt_pk_bf16_f32 v6, v52, v53
    v_lshlrev_b32 v52, 16, v6
    v_and_b32 v53, 0xffff0000, v6
    v_mul_f32 v52, s74, v52
    v_mul_f32 v53, s74, v53
    v_cvt_pk_bf16_f32 v7, v52, v53
    v_lshlrev_b32 v52, 16, v7
    v_and_b32 v53, 0xffff0000, v7
    v_max3_f32 v14, v14, v52, v53
    v_cvt_pk_bf16_f32 v6, v54, v55
    v_lshlrev_b32 v54, 16, v6
    v_and_b32 v55, 0xffff0000, v6
    v_mul_f32 v54, s74, v54
    v_mul_f32 v55, s74, v55
    v_cvt_pk_bf16_f32 v7, v54, v55
    v_lshlrev_b32 v54, 16, v7
    v_and_b32 v55, 0xffff0000, v7
    v_max3_f32 v14, v14, v54, v55
    s_add_u32 s6, s4, 0x500000
    s_waitcnt vmcnt(7)
    buffer_load_dwordx4 v[104:107], v5, s[36:39], s6 offen nt
    v_cvt_pk_bf16_f32 v6, v56, v57
    v_lshlrev_b32 v56, 16, v6
    v_and_b32 v57, 0xffff0000, v6
    v_mul_f32 v56, s74, v56
    v_mul_f32 v57, s74, v57
    v_cvt_pk_bf16_f32 v7, v56, v57
    v_lshlrev_b32 v56, 16, v7
    v_and_b32 v57, 0xffff0000, v7
    v_max3_f32 v14, v14, v56, v57
    v_cvt_pk_bf16_f32 v6, v58, v59
    v_lshlrev_b32 v58, 16, v6
    v_and_b32 v59, 0xffff0000, v6
    v_mul_f32 v58, s74, v58
    v_mul_f32 v59, s74, v59
    v_cvt_pk_bf16_f32 v7, v58, v59
    v_lshlrev_b32 v58, 16, v7
    v_and_b32 v59, 0xffff0000, v7
    v_max3_f32 v14, v14, v58, v59
    v_cvt_pk_bf16_f32 v6, v60, v61
    v_lshlrev_b32 v60, 16, v6
    v_and_b32 v61, 0xffff0000, v6
    v_mul_f32 v60, s74, v60
    v_mul_f32 v61, s74, v61
    v_cvt_pk_bf16_f32 v7, v60, v61
    v_lshlrev_b32 v60, 16, v7
    v_and_b32 v61, 0xffff0000, v7
    v_max3_f32 v14, v14, v60, v61
    v_cvt_pk_bf16_f32 v6, v62, v63
    v_lshlrev_b32 v62, 16, v6
    v_and_b32 v63, 0xffff0000, v6
    v_mul_f32 v62, s74, v62
    v_mul_f32 v63, s74, v63
    v_cvt_pk_bf16_f32 v7, v62, v63
    v_lshlrev_b32 v62, 16, v7
    v_and_b32 v63, 0xffff0000, v7
    v_max3_f32 v14, v14, v62, v63
    s_add_u32 s6, s4, 0x580000
    s_waitcnt vmcnt(7)
    buffer_load_dwordx4 v[108:111], v5, s[36:39], s6 offen nt
    v_mov_b32 v6, v14
    s_nop 1
    v_permlane16_swap_b32 v14, v6
    v_max_f32 v14, v14, v6
    v_mov_b32 v6, v14
    s_nop 1
    v_permlane32_swap_b32 v14, v6
    v_max_f32 v14, v14, v6
    v_sub_f32 v32, v32, v14
    v_mul_f32 v32, s75, v32
    v_exp_f32 v32, v32
    v_sub_f32 v33, v33, v14
    v_mul_f32 v33, s75, v33
    v_exp_f32 v33, v33
    v_sub_f32 v34, v34, v14
    v_mul_f32 v34, s75, v34
    v_exp_f32 v34, v34
    v_sub_f32 v35, v35, v14
    v_mul_f32 v35, s75, v35
    v_exp_f32 v35, v35
    v_sub_f32 v36, v36, v14
    v_mul_f32 v36, s75, v36
    v_exp_f32 v36, v36
    v_sub_f32 v37, v37, v14
    v_mul_f32 v37, s75, v37
    v_exp_f32 v37, v37
    v_sub_f32 v38, v38, v14
    v_mul_f32 v38, s75, v38
    v_exp_f32 v38, v38
    v_sub_f32 v39, v39, v14
    v_mul_f32 v39, s75, v39
    v_exp_f32 v39, v39
    s_add_u32 s6, s4, 0x600000
    s_waitcnt vmcnt(7)
    buffer_load_dwordx4 v[112:115], v5, s[36:39], s6 offen nt
    v_sub_f32 v40, v40, v14
    v_mul_f32 v40, s75, v40
    v_exp_f32 v40, v40
    v_sub_f32 v41, v41, v14
    v_mul_f32 v41, s75, v41
    v_exp_f32 v41, v41
    v_sub_f32 v42, v42, v14
    v_mul_f32 v42, s75, v42
    v_exp_f32 v42, v42
    v_sub_f32 v43, v43, v14
    v_mul_f32 v43, s75, v43
    v_exp_f32 v43, v43
    v_sub_f32 v44, v44, v14
    v_mul_f32 v44, s75, v44
    v_exp_f32 v44, v44
    v_sub_f32 v45, v45, v14
    v_mul_f32 v45, s75, v45
    v_exp_f32 v45, v45
    v_sub_f32 v46, v46, v14
    v_mul_f32 v46, s75, v46
    v_exp_f32 v46, v46
    v_sub_f32 v47, v47, v14
    v_mul_f32 v47, s75, v47
    v_exp_f32 v47, v47
    s_add_u32 s6, s4, 0x680000
    s_waitcnt vmcnt(7)
    buffer_load_dwordx4 v[116:119], v5, s[36:39], s6 offen nt
    v_sub_f32 v48, v48, v14
    v_mul_f32 v48, s75, v48
    v_exp_f32 v48, v48
    v_sub_f32 v49, v49, v14
    v_mul_f32 v49, s75, v49
    v_exp_f32 v49, v49
    v_sub_f32 v50, v50, v14
    v_mul_f32 v50, s75, v50
    v_exp_f32 v50, v50
    v_sub_f32 v51, v51, v14
    v_mul_f32 v51, s75, v51
    v_exp_f32 v51, v51
    v_sub_f32 v52, v52, v14
    v_mul_f32 v52, s75, v52
    v_exp_f32 v52, v52
    v_sub_f32 v53, v53, v14
    v_mul_f32 v53, s75, v53
    v_exp_f32 v53, v53
    v_sub_f32 v54, v54, v14
    v_mul_f32 v54, s75, v54
    v_exp_f32 v54, v54
    v_sub_f32 v55, v55, v14
    v_mul_f32 v55, s75, v55
    v_exp_f32 v55, v55
    s_add_u32 s6, s4, 0x700000
    s_waitcnt vmcnt(7)
    buffer_load_dwordx4 v[120:123], v5, s[36:39], s6 offen nt
    v_sub_f32 v56, v56, v14
    v_mul_f32 v56, s75, v56
    v_exp_f32 v56, v56
    v_sub_f32 v57, v57, v14
    v_mul_f32 v57, s75, v57
    v_exp_f32 v57, v57
    v_sub_f32 v58, v58, v14
    v_mul_f32 v58, s75, v58
    v_exp_f32 v58, v58
    v_sub_f32 v59, v59, v14
    v_mul_f32 v59, s75, v59
    v_exp_f32 v59, v59
    v_sub_f32 v60, v60, v14
    v_mul_f32 v60, s75, v60
    v_exp_f32 v60, v60
    v_sub_f32 v61, v61, v14
    v_mul_f32 v61, s75, v61
    v_exp_f32 v61, v61
    v_sub_f32 v62, v62, v14
    v_mul_f32 v62, s75, v62
    v_exp_f32 v62, v62
    v_sub_f32 v63, v63, v14
    v_mul_f32 v63, s75, v63
    v_exp_f32 v63, v63
    s_add_u32 s6, s4, 0x780000
    s_waitcnt vmcnt(7)
    buffer_load_dwordx4 v[124:127], v5, s[36:39], s6 offen nt
    v_add_f32 v15, v32, v33
    v_add_f32 v15, v15, v34
    v_add_f32 v15, v15, v35
    v_add_f32 v15, v15, v36
    v_add_f32 v15, v15, v37
    v_add_f32 v15, v15, v38
    v_add_f32 v15, v15, v39
    v_add_f32 v15, v15, v40
    v_add_f32 v15, v15, v41
    v_add_f32 v15, v15, v42
    v_add_f32 v15, v15, v43
    v_add_f32 v15, v15, v44
    v_add_f32 v15, v15, v45
    v_add_f32 v15, v15, v46
    v_add_f32 v15, v15, v47
    v_add_f32 v15, v15, v48
    v_add_f32 v15, v15, v49
    v_add_f32 v15, v15, v50
    v_add_f32 v15, v15, v51
    v_add_f32 v15, v15, v52
    v_add_f32 v15, v15, v53
    v_add_f32 v15, v15, v54
    v_add_f32 v15, v15, v55
    v_add_f32 v15, v15, v56
    v_add_f32 v15, v15, v57
    v_add_f32 v15, v15, v58
    v_add_f32 v15, v15, v59
    v_add_f32 v15, v15, v60
    v_add_f32 v15, v15, v61
    v_add_f32 v15, v15, v62
    v_add_f32 v15, v15, v63
    v_cvt_pk_bf16_f32 v240, v32, v33
    v_cvt_pk_bf16_f32 v241, v34, v35
    v_cvt_pk_bf16_f32 v242, v36, v37
    v_cvt_pk_bf16_f32 v243, v38, v39
    v_cvt_pk_bf16_f32 v244, v40, v41
    v_cvt_pk_bf16_f32 v245, v42, v43
    v_cvt_pk_bf16_f32 v246, v44, v45
    v_cvt_pk_bf16_f32 v247, v46, v47
    v_cvt_pk_bf16_f32 v248, v48, v49
    v_cvt_pk_bf16_f32 v249, v50, v51
    v_cvt_pk_bf16_f32 v250, v52, v53
    v_cvt_pk_bf16_f32 v251, v54, v55
    v_cvt_pk_bf16_f32 v252, v56, v57
    v_cvt_pk_bf16_f32 v253, v58, v59
    v_cvt_pk_bf16_f32 v254, v60, v61
    v_cvt_pk_bf16_f32 v255, v62, v63
    v_mov_b32 v6, v15
    s_nop 1
    v_permlane16_swap_b32 v15, v6
    v_add_f32 v15, v15, v6
    v_mov_b32 v6, v15
    s_nop 1
    v_permlane32_swap_b32 v15, v6
    v_add_f32 v15, v15, v6
    v_perm_b32 v224, v68, v64, s72
    v_perm_b32 v225, v76, v72, s72
    v_perm_b32 v226, v84, v80, s72
    v_perm_b32 v227, v92, v88, s72
    v_perm_b32 v228, v68, v64, s73
    v_perm_b32 v229, v76, v72, s73
    v_perm_b32 v230, v84, v80, s73
    v_perm_b32 v231, v92, v88, s73
    v_mfma_f32_16x16x32_bf16 v[192:195], v[224:227], v[240:243], 0
    v_perm_b32 v232, v69, v65, s72
    v_perm_b32 v233, v77, v73, s72
    v_perm_b32 v234, v85, v81, s72
    v_perm_b32 v235, v93, v89, s72
    v_mfma_f32_16x16x32_bf16 v[196:199], v[228:231], v[240:243], 0
    v_perm_b32 v236, v69, v65, s73
    v_perm_b32 v237, v77, v73, s73
    v_perm_b32 v238, v85, v81, s73
    v_perm_b32 v239, v93, v89, s73
    v_mfma_f32_16x16x32_bf16 v[200:203], v[232:235], v[240:243], 0
    v_perm_b32 v224, v70, v66, s72
    v_perm_b32 v225, v78, v74, s72
    v_perm_b32 v226, v86, v82, s72
    v_perm_b32 v227, v94, v90, s72
    v_mfma_f32_16x16x32_bf16 v[204:207], v[236:239], v[240:243], 0
    v_perm_b32 v228, v70, v66, s73
    v_perm_b32 v229, v78, v74, s73
    v_perm_b32 v230, v86, v82, s73
    v_perm_b32 v231, v94, v90, s73
    v_mfma_f32_16x16x32_bf16 v[208:211], v[224:227], v[240:243], 0
    v_perm_b32 v232, v71, v67, s72
    v_perm_b32 v233, v79, v75, s72
    v_perm_b32 v234, v87, v83, s72
    v_perm_b32 v235, v95, v91, s72
    v_mfma_f32_16x16x32_bf16 v[212:215], v[228:231], v[240:243], 0
    v_perm_b32 v236, v71, v67, s73
    v_perm_b32 v237, v79, v75, s73
    v_perm_b32 v238, v87, v83, s73
    v_perm_b32 v239, v95, v91, s73
    v_mfma_f32_16x16x32_bf16 v[216:219], v[232:235], v[240:243], 0
    s_nop 0
    v_mfma_f32_16x16x32_bf16 v[220:223], v[236:239], v[240:243], 0
    s_add_u32 s6, s4, 0x800000
    s_waitcnt vmcnt(7)
    buffer_load_dwordx4 v[128:131], v5, s[36:39], s6 offen nt
    s_add_u32 s6, s4, 0x880000
    s_waitcnt vmcnt(7)
    buffer_load_dwordx4 v[132:135], v5, s[36:39], s6 offen nt
    s_add_u32 s6, s4, 0x900000
    s_waitcnt vmcnt(7)
    buffer_load_dwordx4 v[136:139], v5, s[36:39], s6 offen nt
    s_add_u32 s6, s4, 0x980000
    s_waitcnt vmcnt(7)
    buffer_load_dwordx4 v[140:143], v5, s[36:39], s6 offen nt
    s_add_u32 s6, s4, 0xa00000
    s_waitcnt vmcnt(7)
    buffer_load_dwordx4 v[144:147], v5, s[36:39], s6 offen nt
    s_add_u32 s6, s4, 0xa80000
    s_waitcnt vmcnt(7)
    buffer_load_dwordx4 v[148:151], v5, s[36:39], s6 offen nt
    s_add_u32 s6, s4, 0xb00000
    s_waitcnt vmcnt(7)
    buffer_load_dwordx4 v[152:155], v5, s[36:39], s6 offen nt
    s_add_u32 s6, s4, 0xb80000
    s_waitcnt vmcnt(7)
    buffer_load_dwordx4 v[156:159], v5, s[36:39], s6 offen nt
    v_perm_b32 v224, v100, v96, s72
    v_perm_b32 v225, v108, v104, s72
    v_perm_b32 v226, v116, v112, s72
    v_perm_b32 v227, v124, v120, s72
    v_perm_b32 v228, v100, v96, s73
    v_perm_b32 v229, v108, v104, s73
    v_perm_b32 v230, v116, v112, s73
    v_perm_b32 v231, v124, v120, s73
    v_mfma_f32_16x16x32_bf16 v[192:195], v[224:227], v[244:247], v[192:195]
    v_perm_b32 v232, v101, v97, s72
    v_perm_b32 v233, v109, v105, s72
    v_perm_b32 v234, v117, v113, s72
    v_perm_b32 v235, v125, v121, s72
    v_mfma_f32_16x16x32_bf16 v[196:199], v[228:231], v[244:247], v[196:199]
    v_perm_b32 v236, v101, v97, s73
    v_perm_b32 v237, v109, v105, s73
    v_perm_b32 v238, v117, v113, s73
    v_perm_b32 v239, v125, v121, s73
    v_mfma_f32_16x16x32_bf16 v[200:203], v[232:235], v[244:247], v[200:203]
    v_perm_b32 v224, v102, v98, s72
    v_perm_b32 v225, v110, v106, s72
    v_perm_b32 v226, v118, v114, s72
    v_perm_b32 v227, v126, v122, s72
    v_mfma_f32_16x16x32_bf16 v[204:207], v[236:239], v[244:247], v[204:207]
    v_perm_b32 v228, v102, v98, s73
    v_perm_b32 v229, v110, v106, s73
    v_perm_b32 v230, v118, v114, s73
    v_perm_b32 v231, v126, v122, s73
    v_mfma_f32_16x16x32_bf16 v[208:211], v[224:227], v[244:247], v[208:211]
    v_perm_b32 v232, v103, v99, s72
    v_perm_b32 v233, v111, v107, s72
    v_perm_b32 v234, v119, v115, s72
    v_perm_b32 v235, v127, v123, s72
    v_mfma_f32_16x16x32_bf16 v[212:215], v[228:231], v[244:247], v[212:215]
    v_perm_b32 v236, v103, v99, s73
    v_perm_b32 v237, v111, v107, s73
    v_perm_b32 v238, v119, v115, s73
    v_perm_b32 v239, v127, v123, s73
    v_mfma_f32_16x16x32_bf16 v[216:219], v[232:235], v[244:247], v[216:219]
    s_nop 0
    v_mfma_f32_16x16x32_bf16 v[220:223], v[236:239], v[244:247], v[220:223]
    s_add_u32 s6, s4, 0xc00000
    s_waitcnt vmcnt(7)
    buffer_load_dwordx4 v[160:163], v5, s[36:39], s6 offen nt
    s_add_u32 s6, s4, 0xc80000
    s_waitcnt vmcnt(7)
    buffer_load_dwordx4 v[164:167], v5, s[36:39], s6 offen nt
    s_add_u32 s6, s4, 0xd00000
    s_waitcnt vmcnt(7)
    buffer_load_dwordx4 v[168:171], v5, s[36:39], s6 offen nt
    s_add_u32 s6, s4, 0xd80000
    s_waitcnt vmcnt(7)
    buffer_load_dwordx4 v[172:175], v5, s[36:39], s6 offen nt
    s_add_u32 s6, s4, 0xe00000
    s_waitcnt vmcnt(7)
    buffer_load_dwordx4 v[176:179], v5, s[36:39], s6 offen nt
    s_add_u32 s6, s4, 0xe80000
    s_waitcnt vmcnt(7)
    buffer_load_dwordx4 v[180:183], v5, s[36:39], s6 offen nt
    s_add_u32 s6, s4, 0xf00000
    s_waitcnt vmcnt(7)
    buffer_load_dwordx4 v[184:187], v5, s[36:39], s6 offen nt
    s_add_u32 s6, s4, 0xf80000
    s_waitcnt vmcnt(7)
    buffer_load_dwordx4 v[188:191], v5, s[36:39], s6 offen nt
    v_perm_b32 v224, v132, v128, s72
    v_perm_b32 v225, v140, v136, s72
    v_perm_b32 v226, v148, v144, s72
    v_perm_b32 v227, v156, v152, s72
    v_perm_b32 v228, v132, v128, s73
    v_perm_b32 v229, v140, v136, s73
    v_perm_b32 v230, v148, v144, s73
    v_perm_b32 v231, v156, v152, s73
    v_mfma_f32_16x16x32_bf16 v[192:195], v[224:227], v[248:251], v[192:195]
    v_perm_b32 v232, v133, v129, s72
    v_perm_b32 v233, v141, v137, s72
    v_perm_b32 v234, v149, v145, s72
    v_perm_b32 v235, v157, v153, s72
    v_mfma_f32_16x16x32_bf16 v[196:199], v[228:231], v[248:251], v[196:199]
    v_perm_b32 v236, v133, v129, s73
    v_perm_b32 v237, v141, v137, s73
    v_perm_b32 v238, v149, v145, s73
    v_perm_b32 v239, v157, v153, s73
    v_mfma_f32_16x16x32_bf16 v[200:203], v[232:235], v[248:251], v[200:203]
    v_perm_b32 v224, v134, v130, s72
    v_perm_b32 v225, v142, v138, s72
    v_perm_b32 v226, v150, v146, s72
    v_perm_b32 v227, v158, v154, s72
    v_mfma_f32_16x16x32_bf16 v[204:207], v[236:239], v[248:251], v[204:207]
    v_perm_b32 v228, v134, v130, s73
    v_perm_b32 v229, v142, v138, s73
    v_perm_b32 v230, v150, v146, s73
    v_perm_b32 v231, v158, v154, s73
    v_mfma_f32_16x16x32_bf16 v[208:211], v[224:227], v[248:251], v[208:211]
    v_perm_b32 v232, v135, v131, s72
    v_perm_b32 v233, v143, v139, s72
    v_perm_b32 v234, v151, v147, s72
    v_perm_b32 v235, v159, v155, s72
    v_mfma_f32_16x16x32_bf16 v[212:215], v[228:231], v[248:251], v[212:215]
    v_perm_b32 v236, v135, v131, s73
    v_perm_b32 v237, v143, v139, s73
    v_perm_b32 v238, v151, v147, s73
    v_perm_b32 v239, v159, v155, s73
    v_mfma_f32_16x16x32_bf16 v[216:219], v[232:235], v[248:251], v[216:219]
    s_nop 0
    v_mfma_f32_16x16x32_bf16 v[220:223], v[236:239], v[248:251], v[220:223]
    s_waitcnt vmcnt(0)
    v_lshlrev_b32 v9, 11, v3
    v_lshl_add_u32 v9, v2, 4, v9
    s_lshl_b32 s80, s76, 7
    s_lshr_b32 s81, s3, 1
    s_lshl_b32 s81, s81, 5
    s_add_u32 s80, s80, s81
    s_and_b32 s81, s3, 1
    s_lshl_b32 s81, s81, 2
    s_add_u32 s80, s80, s81
    s_lshl_b32 s80, s80, 11
    s_lshl_b32 s81, s77, 8
    s_add_u32 s80, s80, s81
    s_add_u32 s5, s80, 0
    buffer_load_dwordx4 v[96:99], v9, s[44:47], s5 offen nt
    s_add_u32 s5, s80, 16384
    buffer_load_dwordx4 v[100:103], v9, s[44:47], s5 offen nt
    s_add_u32 s5, s80, 32768
    buffer_load_dwordx4 v[104:107], v9, s[44:47], s5 offen nt
    s_add_u32 s5, s80, 49152
    buffer_load_dwordx4 v[108:111], v9, s[44:47], s5 offen nt
    v_perm_b32 v224, v164, v160, s72
    v_perm_b32 v225, v172, v168, s72
    v_perm_b32 v226, v180, v176, s72
    v_perm_b32 v227, v188, v184, s72
    v_perm_b32 v228, v164, v160, s73
    v_perm_b32 v229, v172, v168, s73
    v_perm_b32 v230, v180, v176, s73
    v_perm_b32 v231, v188, v184, s73
    v_mfma_f32_16x16x32_bf16 v[192:195], v[224:227], v[252:255], v[192:195]
    v_perm_b32 v232, v165, v161, s72
    v_perm_b32 v233, v173, v169, s72
    v_perm_b32 v234, v181, v177, s72
    v_perm_b32 v235, v189, v185, s72
    v_mfma_f32_16x16x32_bf16 v[196:199], v[228:231], v[252:255], v[196:199]
    v_perm_b32 v236, v165, v161, s73
    v_perm_b32 v237, v173, v169, s73
    v_perm_b32 v238, v181, v177, s73
    v_perm_b32 v239, v189, v185, s73
    v_mfma_f32_16x16x32_bf16 v[200:203], v[232:235], v[252:255], v[200:203]
    v_perm_b32 v224, v166, v162, s72
    v_perm_b32 v225, v174, v170, s72
    v_perm_b32 v226, v182, v178, s72
    v_perm_b32 v227, v190, v186, s72
    v_mfma_f32_16x16x32_bf16 v[204:207], v[236:239], v[252:255], v[204:207]
    v_perm_b32 v228, v166, v162, s73
    v_perm_b32 v229, v174, v170, s73
    v_perm_b32 v230, v182, v178, s73
    v_perm_b32 v231, v190, v186, s73
    v_mfma_f32_16x16x32_bf16 v[208:211], v[224:227], v[252:255], v[208:211]
    v_perm_b32 v232, v167, v163, s72
    v_perm_b32 v233, v175, v171, s72
    v_perm_b32 v234, v183, v179, s72
    v_perm_b32 v235, v191, v187, s72
    v_mfma_f32_16x16x32_bf16 v[212:215], v[228:231], v[252:255], v[212:215]
    v_perm_b32 v236, v167, v163, s73
    v_perm_b32 v237, v175, v171, s73
    v_perm_b32 v238, v183, v179, s73
    v_perm_b32 v239, v191, v187, s73
    v_mfma_f32_16x16x32_bf16 v[216:219], v[232:235], v[252:255], v[216:219]
    s_nop 0
    v_mfma_f32_16x16x32_bf16 v[220:223], v[236:239], v[252:255], v[220:223]
    s_mul_i32 s80, s3, 4224
    v_mul_u32_u24 v6, 528, v2
    v_lshl_add_u32 v6, v3, 7, v6
    v_add_u32 v6, s80, v6
    s_mov_b32 s86, 0x00ff00ff
    s_mov_b32 s87, 0x00ff00ff
    s_mov_b64 exec, s[86:87]
    ds_write_b128 v6, v[192:195] offset:8192
    ds_write_b128 v6, v[196:199] offset:8208
    ds_write_b128 v6, v[200:203] offset:8224
    ds_write_b128 v6, v[204:207] offset:8240
    ds_write_b128 v6, v[208:211] offset:8256
    ds_write_b128 v6, v[212:215] offset:8272
    ds_write_b128 v6, v[216:219] offset:8288
    ds_write_b128 v6, v[220:223] offset:8304
    s_mov_b64 exec, 0xff
    s_lshl_b32 s80, s3, 6
    v_lshlrev_b32 v7, 3, v0
    v_add_u32 v7, s80, v7
    ds_write_b64 v7, v[14:15] offset:41984
    s_mov_b64 exec, -1
    s_waitcnt lgkmcnt(0)
    s_barrier
    s_mul_i32 s80, s3, 528
    v_lshlrev_b32 v6, 3, v0
    v_add_u32 v7, s80, v6
    s_lshl_b32 s80, s3, 3
    v_mov_b32 v6, s80
    ds_read_b64 v[208:209], v6 offset:41984
    ds_read_b64 v[210:211], v6 offset:42048
    ds_read_b64 v[212:213], v6 offset:42112
    ds_read_b64 v[214:215], v6 offset:42176
    ds_read_b64 v[216:217], v6 offset:42240
    ds_read_b64 v[218:219], v6 offset:42304
    ds_read_b64 v[220:221], v6 offset:42368
    ds_read_b64 v[222:223], v6 offset:42432
    ds_read_b64 v[192:193], v7 offset:8192
    ds_read_b64 v[194:195], v7 offset:12416
    ds_read_b64 v[196:197], v7 offset:16640
    ds_read_b64 v[198:199], v7 offset:20864
    ds_read_b64 v[200:201], v7 offset:25088
    ds_read_b64 v[202:203], v7 offset:29312
    ds_read_b64 v[204:205], v7 offset:33536
    ds_read_b64 v[206:207], v7 offset:37760
    s_waitcnt lgkmcnt(0)
    v_max3_f32 v14, v208, v210, v212
    v_max3_f32 v14, v14, v214, v216
    v_max3_f32 v14, v14, v218, v220
    v_max_f32 v14, v14, v222
    v_sub_f32 v208, v208, v14
    v_mul_f32 v208, s75, v208
    v_exp_f32 v208, v208
    v_sub_f32 v210, v210, v14
    v_mul_f32 v210, s75, v210
    v_exp_f32 v210, v210
    v_sub_f32 v212, v212, v14
    v_mul_f32 v212, s75, v212
    v_exp_f32 v212, v212
    v_sub_f32 v214, v214, v14
    v_mul_f32 v214, s75, v214
    v_exp_f32 v214, v214
    v_sub_f32 v216, v216, v14
    v_mul_f32 v216, s75, v216
    v_exp_f32 v216, v216
    v_sub_f32 v218, v218, v14
    v_mul_f32 v218, s75, v218
    v_exp_f32 v218, v218
    v_sub_f32 v220, v220, v14
    v_mul_f32 v220, s75, v220
    v_exp_f32 v220, v220
    v_sub_f32 v222, v222, v14
    v_mul_f32 v222, s75, v222
    v_exp_f32 v222, v222
    v_mul_f32 v240, v208, v192
    v_mul_f32 v241, v208, v193
    v_mul_f32 v15, v208, v209
    v_fmac_f32 v240, v210, v194
    v_fmac_f32 v241, v210, v195
    v_fmac_f32 v15, v210, v211
    v_fmac_f32 v240, v212, v196
    v_fmac_f32 v241, v212, v197
    v_fmac_f32 v15, v212, v213
    v_fmac_f32 v240, v214, v198
    v_fmac_f32 v241, v214, v199
    v_fmac_f32 v15, v214, v215
    v_fmac_f32 v240, v216, v200
    v_fmac_f32 v241, v216, v201
    v_fmac_f32 v15, v216, v217
    v_fmac_f32 v240, v218, v202
    v_fmac_f32 v241, v218, v203
    v_fmac_f32 v15, v218, v219
    v_fmac_f32 v240, v220, v204
    v_fmac_f32 v241, v220, v205
    v_fmac_f32 v15, v220, v221
    v_fmac_f32 v240, v222, v206
    v_fmac_f32 v241, v222, v207
    v_fmac_f32 v15, v222, v223
    v_lshrrev_b32 v6, 3, v0
    v_lshlrev_b32 v6, 12, v6
    v_and_b32 v7, 7, v0
    v_lshl_add_u32 v6, v7, 3, v6
    s_lshl_b32 s80, s78, 18
    s_lshl_b32 s81, s3, 15
    s_add_u32 s80, s80, s81
    s_and_b32 s82, s2, 63
    s_lshl_b32 s81, s82, 6
    s_add_u32 s80, s80, s81
    s_add_u32 s80, s80, 0x100000
    buffer_store_dwordx2 v[240:241], v6, s[56:59], s80 offen sc1
    s_lshl_b32 s80, s78, 12
    s_lshl_b32 s81, s3, 9
    s_add_u32 s80, s80, s81
    s_lshl_b32 s81, s82, 3
    s_add_u32 s80, s80, s81
    s_add_u32 s80, s80, 0x200000
    s_mov_b64 exec, 1
    buffer_store_dwordx2 v[14:15], v12, s[56:59], s80 offen sc1
    s_mov_b64 exec, -1
    s_lshl_b32 s85, s76, 9
    s_add_u32 s85, s85, 0x200000
    v_lshlrev_b32 v9, 3, v0
    s_nop 1
L_poll_21:
    buffer_load_dwordx2 v[224:225], v9, s[56:59], s85 offen sc1
    s_waitcnt vmcnt(0)
    v_max_u32 v7, v224, v225
    v_cmp_eq_u32 vcc, -1, v7
    s_nop 3
    s_bcnt1_i32_b64 s80, vcc
    s_cmp_le_u32 s80, 4
    s_cbranch_scc1 L_polld_22
    s_add_u32 s7, s7, 1
    s_cmp_ge_u32 s7, 200000
    s_cbranch_scc1 L_polld_22
    s_sleep 4
    s_branch L_poll_21
L_polld_22:
    s_barrier
    v_lshlrev_b32 v6, 3, v2
    v_lshlrev_b32 v8, 6, v2
    v_lshl_add_u32 v8, v3, 4, v8
    s_lshl_b32 s83, s76, 15
    s_lshl_b32 s81, s3, 12
    s_add_u32 s83, s83, s81
    s_add_u32 s83, s83, 0x100000
L_poll_23:
    buffer_load_dwordx2 v[160:161], v6, s[56:59], s85 offen offset:0 sc1
    buffer_load_dwordx2 v[162:163], v6, s[56:59], s85 offen offset:128 sc1
    buffer_load_dwordx2 v[164:165], v6, s[56:59], s85 offen offset:256 sc1
    buffer_load_dwordx2 v[166:167], v6, s[56:59], s85 offen offset:384 sc1
    buffer_load_dwordx4 v[168:171], v8, s[56:59], s83 offen offset:0 sc1
    buffer_load_dwordx4 v[172:175], v8, s[56:59], s83 offen offset:1024 sc1
    buffer_load_dwordx4 v[176:179], v8, s[56:59], s83 offen offset:2048 sc1
    buffer_load_dwordx4 v[180:183], v8, s[56:59], s83 offen offset:3072 sc1
    s_waitcnt vmcnt(0)
    v_max_u32 v7, v160, v161
    v_max3_u32 v7, v7, v162, v163
    v_max3_u32 v7, v7, v164, v165
    v_max3_u32 v7, v7, v166, v167
    v_max3_u32 v7, v7, v168, v169
    v_max3_u32 v7, v7, v170, v171
    v_max3_u32 v7, v7, v172, v173
    v_max3_u32 v7, v7, v174, v175
    v_max3_u32 v7, v7, v176, v177
    v_max3_u32 v7, v7, v178, v179
    v_max3_u32 v7, v7, v180, v181
    v_max3_u32 v7, v7, v182, v183
    v_cmp_eq_u32 vcc, -1, v7
    s_nop 1
    s_cbranch_vccz L_polld_24
    s_add_u32 s7, s7, 1
    s_cmp_ge_u32 s7, 200000
    s_cbranch_scc1 L_polld_24
    s_sleep 1
    s_branch L_poll_23
L_polld_24:
    v_max3_f32 v14, v160, v162, v164
    v_max_f32 v14, v14, v166
    s_nop 1
    v_max_f32_dpp v14, v14, v14 row_ror:1 row_mask:0xf bank_mask:0xf
    s_nop 1
    v_max_f32_dpp v14, v14, v14 row_ror:2 row_mask:0xf bank_mask:0xf
    s_nop 1
    v_max_f32_dpp v14, v14, v14 row_ror:4 row_mask:0xf bank_mask:0xf
    s_nop 1
    v_max_f32_dpp v14, v14, v14 row_ror:8 row_mask:0xf bank_mask:0xf
    v_sub_f32 v160, v160, v14
    v_mul_f32 v160, s75, v160
    v_exp_f32 v160, v160
    v_sub_f32 v162, v162, v14
    v_mul_f32 v162, s75, v162
    v_exp_f32 v162, v162
    v_sub_f32 v164, v164, v14
    v_mul_f32 v164, s75, v164
    v_exp_f32 v164, v164
    v_sub_f32 v166, v166, v14
    v_mul_f32 v166, s75, v166
    v_exp_f32 v166, v166
    v_mul_f32 v15, v160, v161
    v_mul_f32 v16, v160, v168
    v_mul_f32 v17, v160, v169
    v_mul_f32 v18, v160, v170
    v_mul_f32 v19, v160, v171
    v_fmac_f32 v15, v162, v163
    v_fmac_f32 v16, v162, v172
    v_fmac_f32 v17, v162, v173
    v_fmac_f32 v18, v162, v174
    v_fmac_f32 v19, v162, v175
    v_fmac_f32 v15, v164, v165
    v_fmac_f32 v16, v164, v176
    v_fmac_f32 v17, v164, v177
    v_fmac_f32 v18, v164, v178
    v_fmac_f32 v19, v164, v179
    v_fmac_f32 v15, v166, v167
    v_fmac_f32 v16, v166, v180
    v_fmac_f32 v17, v166, v181
    v_fmac_f32 v18, v166, v182
    v_fmac_f32 v19, v166, v183
    v_add_f32_dpp v15, v15, v15 row_ror:1 row_mask:0xf bank_mask:0xf
    v_add_f32_dpp v16, v16, v16 row_ror:1 row_mask:0xf bank_mask:0xf
    v_add_f32_dpp v17, v17, v17 row_ror:1 row_mask:0xf bank_mask:0xf
    v_add_f32_dpp v18, v18, v18 row_ror:1 row_mask:0xf bank_mask:0xf
    v_add_f32_dpp v19, v19, v19 row_ror:1 row_mask:0xf bank_mask:0xf
    v_add_f32_dpp v15, v15, v15 row_ror:2 row_mask:0xf bank_mask:0xf
    v_add_f32_dpp v16, v16, v16 row_ror:2 row_mask:0xf bank_mask:0xf
    v_add_f32_dpp v17, v17, v17 row_ror:2 row_mask:0xf bank_mask:0xf
    v_add_f32_dpp v18, v18, v18 row_ror:2 row_mask:0xf bank_mask:0xf
    v_add_f32_dpp v19, v19, v19 row_ror:2 row_mask:0xf bank_mask:0xf
    v_add_f32_dpp v15, v15, v15 row_ror:4 row_mask:0xf bank_mask:0xf
    v_add_f32_dpp v16, v16, v16 row_ror:4 row_mask:0xf bank_mask:0xf
    v_add_f32_dpp v17, v17, v17 row_ror:4 row_mask:0xf bank_mask:0xf
    v_add_f32_dpp v18, v18, v18 row_ror:4 row_mask:0xf bank_mask:0xf
    v_add_f32_dpp v19, v19, v19 row_ror:4 row_mask:0xf bank_mask:0xf
    v_add_f32_dpp v15, v15, v15 row_ror:8 row_mask:0xf bank_mask:0xf
    v_add_f32_dpp v16, v16, v16 row_ror:8 row_mask:0xf bank_mask:0xf
    v_add_f32_dpp v17, v17, v17 row_ror:8 row_mask:0xf bank_mask:0xf
    v_add_f32_dpp v18, v18, v18 row_ror:8 row_mask:0xf bank_mask:0xf
    v_add_f32_dpp v19, v19, v19 row_ror:8 row_mask:0xf bank_mask:0xf
    v_rcp_f32 v6, v15
    s_nop 0
    v_mul_f32 v7, v16, v6
    v_fma_f32 v8, -v7, v15, v16
    v_fma_f32 v16, v8, v6, v7
    v_mul_f32 v7, v17, v6
    v_fma_f32 v8, -v7, v15, v17
    v_fma_f32 v17, v8, v6, v7
    v_mul_f32 v7, v18, v6
    v_fma_f32 v8, -v7, v15, v18
    v_fma_f32 v18, v8, v6, v7
    v_mul_f32 v7, v19, v6
    v_fma_f32 v8, -v7, v15, v19
    v_fma_f32 v19, v8, v6, v7
    v_cvt_pk_bf16_f32 v20, v16, v17
    v_cvt_pk_bf16_f32 v21, v18, v19
    v_perm_b32 v224, v100, v96, s72
    v_perm_b32 v225, v108, v104, s72
    v_perm_b32 v228, v100, v96, s73
    v_perm_b32 v229, v108, v104, s73
    v_perm_b32 v232, v101, v97, s72
    v_perm_b32 v233, v109, v105, s72
    v_mfma_f32_16x16x16_bf16 v[192:195], v[20:21], v[224:225], 0
    v_perm_b32 v236, v101, v97, s73
    v_perm_b32 v237, v109, v105, s73
    v_mfma_f32_16x16x16_bf16 v[196:199], v[20:21], v[228:229], 0
    v_perm_b32 v224, v102, v98, s72
    v_perm_b32 v225, v110, v106, s72
    v_mfma_f32_16x16x16_bf16 v[200:203], v[20:21], v[232:233], 0
    v_perm_b32 v228, v102, v98, s73
    v_perm_b32 v229, v110, v106, s73
    v_mfma_f32_16x16x16_bf16 v[204:207], v[20:21], v[236:237], 0
    v_perm_b32 v232, v103, v99, s72
    v_perm_b32 v233, v111, v107, s72
    v_mov_b32 v64, v192
    v_mfma_f32_16x16x16_bf16 v[192:195], v[20:21], v[224:225], 0
    v_perm_b32 v236, v103, v99, s73
    v_perm_b32 v237, v111, v107, s73
    v_mov_b32 v65, v196
    v_mfma_f32_16x16x16_bf16 v[196:199], v[20:21], v[228:229], 0
    v_mov_b32 v66, v200
    v_mfma_f32_16x16x16_bf16 v[200:203], v[20:21], v[232:233], 0
    v_mov_b32 v67, v204
    v_mfma_f32_16x16x16_bf16 v[204:207], v[20:21], v[236:237], 0
    v_mov_b32 v68, v192
    s_nop 2
    v_mov_b32 v69, v196
    s_nop 0
    v_mov_b32 v70, v200
    s_nop 0
    v_mov_b32 v71, v204
    v_mov_b32 v72, 0
    v_mov_b32 v73, 0
    v_mov_b32 v74, 0
    v_mov_b32 v75, 0
    v_mov_b32 v76, 0
    v_mov_b32 v77, 0
    v_mov_b32 v78, 0
    v_mov_b32 v79, 0
    s_lshl_b32 s80, s3, 10
    v_lshlrev_b32 v6, 5, v2
    v_add_u32 v6, s80, v6
    s_mov_b64 exec, 0xffff
    ds_write_b128 v6, v[64:67] offset:42496
    ds_write_b128 v6, v[68:71] offset:42512
    ds_write_b128 v6, v[72:75] offset:43008
    ds_write_b128 v6, v[76:79] offset:43024
    s_mov_b64 exec, -1
    s_waitcnt lgkmcnt(0)
    s_barrier
    s_lshl_b32 s85, s77, 8
    s_lshl_b32 s81, s76, 3
    s_add_u32 s85, s85, s81
    buffer_load_dwordx2 v[24:25], v12, s[60:63], s85 offen
    ds_read_b128 v[128:131], v5 offset:42496
    ds_read_b128 v[132:135], v5 offset:43520
    ds_read_b128 v[136:139], v5 offset:44544
    ds_read_b128 v[140:143], v5 offset:45568
    ds_read_b128 v[144:147], v5 offset:46592
    ds_read_b128 v[148:151], v5 offset:47616
    ds_read_b128 v[152:155], v5 offset:48640
    ds_read_b128 v[156:159], v5 offset:49664
    s_waitcnt lgkmcnt(0)
    v_add_f32 v128, v128, v132
    v_add_f32 v129, v129, v133
    v_add_f32 v130, v130, v134
    v_add_f32 v131, v131, v135
    v_add_f32 v128, v128, v136
    v_add_f32 v129, v129, v137
    v_add_f32 v130, v130, v138
    v_add_f32 v131, v131, v139
    v_add_f32 v128, v128, v140
    v_add_f32 v129, v129, v141
    v_add_f32 v130, v130, v142
    v_add_f32 v131, v131, v143
    v_add_f32 v128, v128, v144
    v_add_f32 v129, v129, v145
    v_add_f32 v130, v130, v146
    v_add_f32 v131, v131, v147
    v_add_f32 v128, v128, v148
    v_add_f32 v129, v129, v149
    v_add_f32 v130, v130, v150
    v_add_f32 v131, v131, v151
    v_add_f32 v128, v128, v152
    v_add_f32 v129, v129, v153
    v_add_f32 v130, v130, v154
    v_add_f32 v131, v131, v155
    v_add_f32 v128, v128, v156
    v_add_f32 v129, v129, v157
    v_add_f32 v130, v130, v158
    v_add_f32 v131, v131, v159
    s_lshl_b32 s83, s77, 15
    s_add_u32 s83, s83, 0x400000
    v_and_b32 v6, 31, v0
    v_lshlrev_b32 v6, 10, v6
    v_lshrrev_b32 v7, 5, v0
    v_lshl_add_u32 v6, v7, 9, v6
    s_lshl_b32 s81, s76, 4
    s_add_u32 s81, s83, s81
    buffer_store_dwordx4 v[128:131], v6, s[56:59], s81 offen sc1
    s_lshl_b32 s81, s76, 10
    s_add_u32 s83, s83, s81
    v_mov_b32 v6, v5
    s_nop 1
L_poll_25:
    buffer_load_dwordx4 v[160:163], v6, s[56:59], s83 offen sc1
    s_waitcnt vmcnt(0)
    v_max_u32 v7, v160, v161
    v_max3_u32 v7, v7, v162, v163
    v_cmp_eq_u32 vcc, -1, v7
    s_nop 1
    s_cbranch_vccz L_polld_26
    s_add_u32 s7, s7, 1
    s_cmp_ge_u32 s7, 200000
    s_cbranch_scc1 L_polld_26
    s_sleep 1
    s_branch L_poll_25
L_polld_26:
    v_add_f32_dpp v160, v160, v160 row_ror:1 row_mask:0xf bank_mask:0xf
    v_add_f32_dpp v161, v161, v161 row_ror:1 row_mask:0xf bank_mask:0xf
    v_add_f32_dpp v162, v162, v162 row_ror:1 row_mask:0xf bank_mask:0xf
    v_add_f32_dpp v163, v163, v163 row_ror:1 row_mask:0xf bank_mask:0xf
    v_add_f32_dpp v160, v160, v160 row_ror:2 row_mask:0xf bank_mask:0xf
    v_add_f32_dpp v161, v161, v161 row_ror:2 row_mask:0xf bank_mask:0xf
    v_add_f32_dpp v162, v162, v162 row_ror:2 row_mask:0xf bank_mask:0xf
    v_add_f32_dpp v163, v163, v163 row_ror:2 row_mask:0xf bank_mask:0xf
    v_add_f32_dpp v160, v160, v160 row_ror:4 row_mask:0xf bank_mask:0xf
    v_add_f32_dpp v161, v161, v161 row_ror:4 row_mask:0xf bank_mask:0xf
    v_add_f32_dpp v162, v162, v162 row_ror:4 row_mask:0xf bank_mask:0xf
    v_add_f32_dpp v163, v163, v163 row_ror:4 row_mask:0xf bank_mask:0xf
    v_add_f32_dpp v160, v160, v160 row_ror:8 row_mask:0xf bank_mask:0xf
    v_add_f32_dpp v161, v161, v161 row_ror:8 row_mask:0xf bank_mask:0xf
    v_add_f32_dpp v162, v162, v162 row_ror:8 row_mask:0xf bank_mask:0xf
    v_add_f32_dpp v163, v163, v163 row_ror:8 row_mask:0xf bank_mask:0xf
    v_mov_b32 v164, v160
    v_mov_b32 v165, v161
    v_mov_b32 v166, v162
    v_mov_b32 v167, v163
    v_permlane16_swap_b32 v160, v164
    v_permlane16_swap_b32 v161, v165
    v_permlane16_swap_b32 v162, v166
    v_permlane16_swap_b32 v163, v167
    v_add_f32 v160, v160, v164
    v_add_f32 v161, v161, v165
    v_add_f32 v162, v162, v166
    v_add_f32 v163, v163, v167
    v_mov_b32 v164, v160
    v_mov_b32 v165, v161
    v_mov_b32 v166, v162
    v_mov_b32 v167, v163
    v_permlane32_swap_b32 v160, v164
    v_permlane32_swap_b32 v161, v165
    v_permlane32_swap_b32 v162, v166
    v_permlane32_swap_b32 v163, v167
    v_lshlrev_b32 v168, 16, v24
    v_and_b32 v169, 0xffff0000, v24
    v_lshlrev_b32 v170, 16, v25
    v_and_b32 v171, 0xffff0000, v25
    v_cvt_pk_bf16_f32 v6, v160, v161
    v_lshlrev_b32 v160, 16, v6
    v_and_b32 v161, 0xffff0000, v6
    v_cvt_pk_bf16_f32 v6, v164, v165
    v_lshlrev_b32 v164, 16, v6
    v_and_b32 v165, 0xffff0000, v6
    v_cvt_pk_bf16_f32 v6, v162, v163
    v_lshlrev_b32 v162, 16, v6
    v_and_b32 v163, 0xffff0000, v6
    v_cvt_pk_bf16_f32 v6, v166, v167
    v_lshlrev_b32 v166, 16, v6
    v_and_b32 v167, 0xffff0000, v6
    v_add_f32 v160, v160, v168
    v_add_f32 v161, v161, v169
    v_add_f32 v162, v162, v170
    v_add_f32 v163, v163, v171
    v_cvt_pk_bf16_f32 v6, v160, v161
    v_lshlrev_b32 v160, 16, v6
    v_and_b32 v161, 0xffff0000, v6
    v_cvt_pk_bf16_f32 v6, v162, v163
    v_lshlrev_b32 v162, 16, v6
    v_and_b32 v163, 0xffff0000, v6
    v_add_f32 v160, v160, v164
    v_add_f32 v161, v161, v165
    v_add_f32 v162, v162, v166
    v_add_f32 v163, v163, v167
    v_cvt_pk_bf16_f32 v168, v160, v161
    v_cvt_pk_bf16_f32 v169, v162, v163
    s_mov_b64 exec, 1
    buffer_store_dwordx2 v[168:169], v12, s[64:67], s85 offen
    s_endpgm
L_end:
    s_endpgm

.section .rodata,"a"
.p2align 6
.amdhsa_kernel parallel_sum__gqa_block_cached__geglu_ffn__decode_kernel
  .amdhsa_next_free_vgpr 256
  .amdhsa_next_free_sgpr 102
  .amdhsa_accum_offset 256
  .amdhsa_group_segment_fixed_size 0
  .amdhsa_kernarg_size 96
  .amdhsa_user_sgpr_count 2
  .amdhsa_user_sgpr_kernarg_segment_ptr 1
  .amdhsa_system_sgpr_workgroup_id_x 1
  .amdhsa_float_denorm_mode_32 3
.end_amdhsa_kernel
```
